```python
import torch

def _softmax(x, axis=-1):
    return torch.softmax(x, dim=axis)
def _gelu(x):
    return torch.nn.functional.gelu(x, approximate="tanh")
def _silu(x):
    return torch.nn.functional.silu(x)
def _sigmoid(x):
    return torch.sigmoid(x)
def _layernorm(x, axis=-1, eps=1e-5):
    m = x.mean(dim=axis, keepdim=True)
    v = x.var(dim=axis, keepdim=True, unbiased=False)
    return (x - m) / torch.sqrt(v + eps)
def _scatter_add(tgt, idx, src, axis=0):
    return tgt.clone().index_add_(axis, idx, src)
def _segment_sum(src, seg, n):
    out = torch.zeros((n,) + src.shape[1:], dtype=src.dtype)
    return out.index_add_(0, seg, src)
def _pad(x, pw):
    flat = tuple(v for pair in reversed(pw) for v in pair)
    return torch.nn.functional.pad(x, flat)

kernel_name = 'interleave_layers__sliding_block__glu_gated_swiglu__prompt'

def setup_inputs():

    _w = (lambda a: (lambda t: t.to(torch.bfloat16) if t.is_floating_point() else t)(torch.as_tensor(a)))
    def _A_setup():
        B, S, D = 1, 2048, 640
        return {
            "x": _w((lambda *s: torch.randn(*s, dtype=torch.bfloat16) * 0.05)(B, S, D)),
            "wqkv": _w((lambda *s: torch.randn(*s, dtype=torch.bfloat16) * 0.05)(D, 3 * D)),
            "wo": _w((lambda *s: torch.randn(*s, dtype=torch.bfloat16) * 0.05)(D, D)),
        }
    _A_in = _A_setup()

    def _B_setup():
        B, S, D, F = 1, 2048, 640, 1728
        return {
            "x": _w((lambda *s: torch.randn(*s, dtype=torch.bfloat16) * 0.05)(B, S, D)),
            "w1": _w((lambda *s: torch.randn(*s, dtype=torch.bfloat16) * 0.8)(D, F) * (2.0 / D) ** 0.5),
            "w3": _w((lambda *s: torch.randn(*s, dtype=torch.bfloat16) * 0.8)(D, F) * (2.0 / D) ** 0.5),
            "w2": _w((lambda *s: torch.randn(*s, dtype=torch.bfloat16) * 0.8)(F, D) * (2.0 / F) ** 0.5),
        }
    _B_in = _B_setup()

    return {
        "A_x": _A_in["x"],
        "A_wqkv": _A_in["wqkv"],
        "A_wo": _A_in["wo"],
        "B_x": _B_in["x"],
        "B_w1": _B_in["w1"],
        "B_w3": _B_in["w3"],
        "B_w2": _B_in["w2"],
    }

def reference(A_x, A_wqkv, A_wo, B_x, B_w1, B_w3, B_w2):
    def _A_ref(x, wqkv, wo):
        B, S, D = x.shape
        H = 32; Dh = D // H; W = 256
        qkv = (lambda x, *d: x.permute(*d))((x @ wqkv).reshape(B, S, 3, H, Dh), 2, 0, 3, 1, 4)
        q, k, v = qkv[0], qkv[1], qkv[2]
        scores = torch.einsum("bhqd,bhkd->bhqk", q, k) * (Dh ** -0.5)
        idx = torch.arange(S)
        mask = (idx[:, None] - idx[None, :] >= 0) & (idx[:, None] - idx[None, :] < W)
        scores = torch.where(mask[None, None], scores, -1e9)
        p = _softmax(scores, axis=-1)
        o = torch.einsum("bhqk,bhkd->bhqd", p, v)
        return (lambda x, *d: x.permute(*d))(o, 0, 2, 1, 3).reshape(B, S, D) @ wo

    def _B_ref(x, w1, w3, w2):
        gate = torch.einsum("bsd,df->bsf", x, w1)
        up = torch.einsum("bsd,df->bsf", x, w3)
        h = _silu(gate) * up
        out = torch.einsum("bsf,fd->bsd", h, w2)
        return out

    x = A_x
    x = x + _A_ref(_layernorm(x, axis=-1), A_wqkv, A_wo)
    x = x + _B_ref(_layernorm(x, axis=-1), B_w1, B_w3, B_w2)
    x = x + _A_ref(_layernorm(x, axis=-1), A_wqkv, A_wo)
    x = x + _B_ref(_layernorm(x, axis=-1), B_w1, B_w3, B_w2)
    return x
```

```asm
; @launch grid=(256,1,1) block=(256,1,1) lds=163840
.amdgcn_target "amdgcn-amd-amdhsa--gfx950"
.text
.globl interleave_layers__sliding_block__glu_gated_swiglu__prompt_kernel
.p2align 8
.type interleave_layers__sliding_block__glu_gated_swiglu__prompt_kernel,@function
interleave_layers__sliding_block__glu_gated_swiglu__prompt_kernel:
  s_cmp_ge_u32 s2, 256
  s_cbranch_scc1 L_end
  s_load_dwordx16 s[64:79], s[0:1], 0
  s_load_dwordx4 s[4:7], s[0:1], 64
  s_memrealtime s[26:27]
  v_lshrrev_b32 v1, 6, v0
  v_and_b32 v5, 63, v0
  v_readfirstlane_b32 s18, v1
  s_bfe_u32 s30, s2, 0x20001
  s_lshl_b32 s30, s30, 2
  s_lshr_b32 s31, s2, 6
  s_add_u32 s16, s30, s31
  s_and_b32 s30, s2, 1
  s_lshl_b32 s30, s30, 3
  s_bfe_u32 s31, s2, 0x30003
  s_add_u32 s17, s30, s31
  s_lshr_b32 s30, s17, 3
  s_lshl_b32 s30, s30, 2
  s_and_b32 s31, s17, 3
  s_add_u32 s20, s30, s31
  s_bfe_u32 s21, s17, 0x10002
  s_mov_b32 s19, 0
  s_lshl_b32 s30, s17, 2
  s_add_u32 s30, s30, s18
  s_lshl_b32 s22, s30, 7
  s_mul_i32 s43, s18, 14
  s_mul_i32 s33, s20, 54
  s_add_u32 s33, s33, s43
  s_mul_i32 s52, s33, 5120
  s_add_u32 s52, s52, 9863168
  s_cmp_ge_u32 s18, 3
  s_cselect_b32 s53, 0x40000000, 0
  v_lshlrev_b32 v1, 4, v5
  v_add_u32 v2, 0x10000, v1
  v_add_u32 v3, 0x20000, v1
  v_mov_b32 v4, 0
  v_and_b32 v6, 32, v5
  v_lshlrev_b32 v6, 1, v6
  v_and_b32 v7, 31, v5
  v_lshlrev_b32 v7, 3, v7
  v_lshl_add_u32 v7, v6, 10, v7
  v_and_b32 v14, 15, v5
  v_bfe_u32 v15, v5, 4, 1
  v_lshlrev_b32 v8, 2, v6
  v_lshl_add_u32 v8, v14, 4, v8
  v_mul_u32_u24 v9, 55296, v15
  v_add_u32 v9, v9, v8
  v_mul_u32_u24 v15, 20480, v15
  v_add_u32 v8, v8, v15
  v_lshrrev_b32 v15, 4, v5
  v_lshlrev_b32 v10, 9, v15
  v_lshl_add_u32 v10, v14, 4, v10
  v_lshlrev_b32 v11, 3, v6
  v_lshl_add_u32 v11, v14, 4, v11
  v_and_b32 v12, 16, v5
  v_lshrrev_b32 v12, 1, v12
  v_add_u32 v11, v11, v12
  v_mul_u32_u24 v13, 1280, v14
  v_lshl_add_u32 v12, v15, 4, v13
  v_lshl_add_u32 v13, v15, 3, v13
  s_waitcnt lgkmcnt(0)
  s_mov_b32 s8, s6
  s_mov_b32 s9, s7
  s_mov_b32 s10, 55562240
  s_mov_b32 s11, 0x20000
  s_mov_b32 s12, s78
  s_mov_b32 s13, s79
  s_mov_b32 s14, 2621440
  s_mov_b32 s15, 0x20000
  s_mul_i32 s40, s17, 286720
  s_mul_i32 s41, s18, 5120
  s_add_u32 s40, s40, s41
  s_add_u32 s40, s40, 5275648
  s_mov_b32 s84, s4
  s_mov_b32 s85, s5
  s_mov_b32 s86, 256
  s_mov_b32 s87, 0x20000
  s_or_b32 s30, s2, s18
  s_cbranch_scc1 L_nn
  s_or_b32 s26, s26, 1
  v_mov_b32 v14, s26
  buffer_store_dword v14, v4, s[84:87], 0 offen sc1
L_nn:
  s_mov_b32 s80, s64
  s_mov_b32 s81, s65
  s_mov_b32 s82, 2621440
  s_mov_b32 s83, 0x20000
  s_lshl_b32 s88, s16, 4
  s_add_u32 s88, s88, s17
  s_mul_i32 s88, s88, 3072
  s_add_u32 s88, s88, 12570624
  s_lshl_b32 s36, s16, 3
  s_lshl_b32 s37, s21, 2
  s_add_u32 s36, s36, s37
  s_add_u32 s36, s36, s18
  s_mul_i32 s89, s36, 20480
  s_mul_i32 s37, s20, 160
  s_add_u32 s89, s89, s37
  s_getpc_b64 s[30:31]
L_pc:
  s_lshr_b32 s33, s2, 3
  s_lshl_b32 s33, s33, 11
  v_lshl_add_u32 v14, v0, 3, s33
  v_min_u32 v14, L_end-L_pc, v14
  v_mov_b32 v15, s31
  v_add_co_u32 v14, vcc, s30, v14
  v_addc_co_u32 v15, vcc, 0, v15, vcc
  global_load_dword v210, v[14:15], off
  s_mov_b32 s28, 0x05040100
  s_mov_b32 s29, 0x07060302
  s_mov_b32 s27, 0x3f803f80
  s_lshl_b32 s30, s17, 4
  s_add_u32 s30, s30, s16
  s_mul_i32 s44, s30, 1408
  s_add_u32 s44, s44, 12206080
  s_mul_i32 s45, s16, 5
  v_lshlrev_b32 v28, 5, v0
  v_mov_b32 v98, 0
  v_mov_b32 v99, 0
  v_mov_b32 v100, 0x7fffff00
  v_mov_b32 v101, 0x7fffff00
  s_cmp_eq_u32 s18, 3
  s_cbranch_scc1 PX
  s_mov_b32 s36, s66
  s_mov_b32 s37, s67
  s_mov_b32 s38, 2457600
  s_mov_b32 s39, 0x20000
  v_mul_u32_u24 v16, 137, v0
  v_lshrrev_b32 v16, 11, v16
  v_mul_u32_u24 v17, 15, v16
  v_sub_u32 v17, v0, v17
  v_mul_u32_u24 v18, 52, v17
  v_lshrrev_b32 v18, 8, v18
  v_mul_u32_u24 v19, 5, v18
  v_sub_u32 v19, v17, v19
  v_lshlrev_b32 v29, 11, v16
  v_add_u32 v29, 16384, v29
  v_add_u32 v16, s45, v16
  v_mul_u32_u24 v96, 30720, v16
  v_mul_u32_u24 v97, 1280, v18
  v_lshl_add_u32 v97, v19, 4, v97
  s_mul_i32 s30, s17, 80
  v_add3_u32 v96, v96, v97, s30
  v_add_u32 v97, 15360, v96
  v_cmp_gt_u32 vcc, 75, v0
  s_and_b64 exec, exec, vcc
  s_cbranch_execz PQ1
  s_mov_b32 s33, 3840
  s_mov_b32 s34, 7680
  s_mov_b32 s35, 11520
  buffer_load_dwordx4 v[32:35], v96, s[36:39], 0 offen
  buffer_load_dwordx4 v[36:39], v96, s[36:39], s33 offen
  buffer_load_dwordx4 v[40:43], v96, s[36:39], s34 offen
  buffer_load_dwordx4 v[44:47], v96, s[36:39], s35 offen
  buffer_load_dwordx4 v[48:51], v97, s[36:39], 0 offen
  buffer_load_dwordx4 v[52:55], v97, s[36:39], s33 offen
  buffer_load_dwordx4 v[56:59], v97, s[36:39], s34 offen
  buffer_load_dwordx4 v[60:63], v97, s[36:39], s35 offen
PQ1:
  s_mov_b64 exec, -1
  v_mov_b32 v96, v18
  v_mov_b32 v97, v19
  s_branch PR2
PX:
  s_mov_b32 s36, s64
  s_mov_b32 s37, s65
  s_mov_b32 s38, 2621440
  s_mov_b32 s39, 0x20000
  s_lshl_b32 s30, s16, 4
  s_add_u32 s30, s30, s17
  s_mul_i32 s33, s30, 10240
  v_lshrrev_b32 v16, 3, v5
  v_and_b32 v17, 7, v5
  v_mul_u32_u24 v18, 1280, v17
  v_mul_u32_u24 v19, 160, v16
  v_add_u32 v18, v18, v19
  buffer_load_dwordx4 v[32:35], v18, s[36:39], s33 offen offset:0
  buffer_load_dwordx4 v[36:39], v18, s[36:39], s33 offen offset:16
  buffer_load_dwordx4 v[40:43], v18, s[36:39], s33 offen offset:32
  buffer_load_dwordx4 v[44:47], v18, s[36:39], s33 offen offset:48
  buffer_load_dwordx4 v[48:51], v18, s[36:39], s33 offen offset:64
  buffer_load_dwordx4 v[52:55], v18, s[36:39], s33 offen offset:80
  buffer_load_dwordx4 v[56:59], v18, s[36:39], s33 offen offset:96
  buffer_load_dwordx4 v[60:63], v18, s[36:39], s33 offen offset:112
  buffer_load_dwordx4 v[64:67], v18, s[36:39], s33 offen offset:128
  buffer_load_dwordx4 v[68:71], v18, s[36:39], s33 offen offset:144
  s_lshr_b32 s33, s30, 2
  s_mul_i32 s33, s33, 40960
  s_and_b32 s34, s30, 3
  s_lshl_b32 s34, s34, 7
  s_add_u32 s46, s33, s34
  s_add_u32 s46, s46, 13357056
  s_add_u32 s47, s46, 2560
  s_lshl_b32 s48, s30, 6
  s_add_u32 s48, s48, 23842816
  v_mul_u32_u24 v98, 5120, v16
  v_lshl_add_u32 v98, v17, 4, v98
  v_lshlrev_b32 v99, 14, v16
  v_lshl_add_u32 v99, v17, 3, v99
PR2:
  v_cmp_le_u32 vcc, 70, v0
  v_subrev_u32 v16, 70, v0
  s_nop 0
  v_cndmask_b32 v16, v0, v16, vcc
  v_cndmask_b32 v108, 0, 1, vcc
  v_mul_u32_u24 v109, 147, v16
  v_lshrrev_b32 v109, 11, v109
  v_mul_u32_u24 v17, 14, v109
  v_sub_u32 v17, v16, v17
  v_add_u32 v16, s45, v109
  s_mul_i32 s30, s17, 224
  s_mul_i32 s31, s17, 192
  s_add_u32 s31, s31, 384
  s_min_u32 s30, s30, s31
  v_mul_u32_u24 v102, 27648, v16
  v_lshlrev_b32 v18, 4, v17
  v_add3_u32 v102, v102, v18, s30
  v_add_u32 v103, 13824, v102
  v_lshrrev_b32 v18, 1, v17
  v_and_b32 v19, 1, v17
  v_lshl_add_u32 v19, v108, 2, v19
  v_lshl_add_u32 v106, v18, 3, v19
  v_lshl_add_u32 v106, v106, 4, s44
  v_add_u32 v106, 512, v106
  v_add_u32 v107, 32, v106
  v_mul_u32_u24 v21, 7, v109
  v_add_u32 v21, v21, v18
  v_lshl_add_u32 v21, v21, 3, v19
  v_lshlrev_b32 v104, 6, v21
  v_add_u32 v104, 32768, v104
  v_add_u32 v105, 128, v104
  s_cmp_ge_u32 s17, 12
  s_cselect_b32 s30, 6, 7
  v_cmp_le_u32 vcc, s30, v18
  s_nop 1
  v_cndmask_b32 v108, v108, 4, vcc
  v_cmp_le_u32 vcc, 140, v0
  s_and_b64 exec, exec, vcc
  s_cbranch_execz PN
  v_subrev_u32 v16, 140, v0
  v_mul_u32_u24 v17, 205, v16
  v_lshrrev_b32 v17, 11, v17
  v_mul_u32_u24 v18, 10, v17
  v_sub_u32 v18, v16, v18
  s_lshl_b32 s30, s16, 1
  s_add_u32 s30, s30, s21
  v_mul_u32_u24 v21, 1280, v17
  v_add_u32 v21, 51200, v21
  v_lshl_add_u32 v17, v17, 5, s30
  v_mov_b32 v109, 1
  v_mul_u32_u24 v22, 205, v17
  v_lshrrev_b32 v22, 10, v22
  v_mul_u32_u24 v23, 5, v22
  v_sub_u32 v23, v17, v23
  v_mul_u32_u24 v22, 40, v22
  v_lshrrev_b32 v24, 1, v23
  v_mul_u32_u24 v24, 20, v24
  v_and_b32 v25, 1, v23
  v_lshl_add_u32 v24, v25, 2, v24
  v_cmp_eq_u32 vcc, 4, v23
  s_nop 1
  v_cndmask_b32 v24, v24, 16, vcc
  v_cndmask_b32 v26, 8, 20, vcc
  v_add_u32 v102, v22, v24
  v_add_u32 v103, v102, v26
  v_subrev_u32 v20, 80, v17
  v_lshrrev_b32 v22, 1, v20
  v_mul_u32_u24 v23, 147, v22
  v_lshrrev_b32 v23, 12, v23
  v_mul_u32_u24 v24, 28, v23
  v_sub_u32 v22, v22, v24
  v_cmp_eq_u32 vcc, 3, v23
  v_mov_b32 v26, 86
  v_mov_b32 v27, 128
  v_cndmask_b32 v25, 7, 6, vcc
  v_cndmask_b32 v26, v26, v27, vcc
  v_and_b32 v27, 15, v22
  v_mul_u32_u24 v26, v27, v26
  v_lshrrev_b32 v26, 8, v26
  v_lshl_add_u32 v26, v26, 2, v27
  v_add_u32 v26, 4, v26
  v_lshrrev_b32 v27, 2, v22
  v_mul_u32_u24 v27, v27, v25
  v_and_b32 v25, 3, v22
  v_add_u32 v27, v27, v25
  v_cmp_gt_u32 vcc, 16, v22
  s_nop 1
  v_cndmask_b32 v26, v26, v27, vcc
  v_add_u32 v26, v26, v24
  v_and_b32 v27, 1, v20
  v_lshl_add_u32 v26, v26, 1, v27
  v_lshlrev_b32 v26, 3, v26
  v_add_u32 v27, 4, v26
  v_cmp_le_u32 vcc, 80, v17
  s_nop 1
  v_cndmask_b32 v102, v102, v26, vcc
  v_cndmask_b32 v103, v103, v27, vcc
  v_cndmask_b32 v108, 2, 3, vcc
  v_cmp_le_u32 vcc, 296, v17
  s_nop 1
  v_cndmask_b32 v108, v108, 4, vcc
  s_mul_i32 s30, s20, 160
  v_lshl_add_u32 v22, v18, 4, s30
  v_mul_u32_u24 v102, 1280, v102
  v_add_u32 v102, v102, v22
  v_mul_u32_u24 v103, 1280, v103
  v_add_u32 v103, v103, v22
  v_lshrrev_b32 v22, 2, v18
  v_lshlrev_b32 v22, 1, v22
  v_and_b32 v23, 3, v18
  v_lshlrev_b32 v24, 1, v23
  v_cmp_le_u32 vcc, 8, v18
  v_mov_b32 v25, 256
  s_nop 0
  v_cndmask_b32 v23, v23, v24, vcc
  v_cndmask_b32 v25, v25, 64, vcc
  v_lshl_add_u32 v22, v22, 2, v23
  v_lshl_add_u32 v104, v22, 6, v21
  v_add_u32 v105, v104, v25
PN:
  s_mov_b64 exec, -1
  s_cmp_ge_u32 s18, 2
  s_cbranch_scc1 PLU
  v_lshl_add_u32 v20, v97, 1, 0
  v_cmp_le_u32 vcc, 5, v20
  v_subrev_u32 v21, 5, v20
  s_nop 0
  v_cndmask_b32 v20, v20, v21, vcc
  v_cndmask_b32 v21, 0, 1, vcc
  v_lshl_add_u32 v21, v96, 1, v21
  v_mov_b32 v22, 30137012
  v_cmp_eq_u32 vcc, 1, v21
  v_mov_b32 v23, 31320888
  s_nop 0
  v_cndmask_b32 v22, v22, v23, vcc
  v_cmp_eq_u32 vcc, 2, v21
  v_mov_b32 v23, 16877600
  s_nop 0
  v_cndmask_b32 v22, v22, v23, vcc
  v_cmp_eq_u32 vcc, 3, v21
  v_mov_b32 v23, 18061476
  s_nop 0
  v_cndmask_b32 v22, v22, v23, vcc
  v_cmp_eq_u32 vcc, 4, v21
  v_mov_b32 v23, 19245352
  s_nop 0
  v_cndmask_b32 v22, v22, v23, vcc
  v_cmp_eq_u32 vcc, 5, v21
  v_mov_b32 v23, 20429228
  s_nop 0
  v_cndmask_b32 v22, v22, v23, vcc
  v_mul_u32_u24 v20, 5, v20
  v_lshrrev_b32 v22, v20, v22
  v_and_b32 v22, 31, v22
  v_lshl_add_u32 v100, v22, 4, s44
  v_lshl_add_u32 v98, v22, 6, v29
  v_lshl_add_u32 v20, v97, 1, 1
  v_cmp_le_u32 vcc, 5, v20
  v_subrev_u32 v21, 5, v20
  s_nop 0
  v_cndmask_b32 v20, v20, v21, vcc
  v_cndmask_b32 v21, 0, 1, vcc
  v_lshl_add_u32 v21, v96, 1, v21
  v_mov_b32 v22, 30137012
  v_cmp_eq_u32 vcc, 1, v21
  v_mov_b32 v23, 31320888
  s_nop 0
  v_cndmask_b32 v22, v22, v23, vcc
  v_cmp_eq_u32 vcc, 2, v21
  v_mov_b32 v23, 16877600
  s_nop 0
  v_cndmask_b32 v22, v22, v23, vcc
  v_cmp_eq_u32 vcc, 3, v21
  v_mov_b32 v23, 18061476
  s_nop 0
  v_cndmask_b32 v22, v22, v23, vcc
  v_cmp_eq_u32 vcc, 4, v21
  v_mov_b32 v23, 19245352
  s_nop 0
  v_cndmask_b32 v22, v22, v23, vcc
  v_cmp_eq_u32 vcc, 5, v21
  v_mov_b32 v23, 20429228
  s_nop 0
  v_cndmask_b32 v22, v22, v23, vcc
  v_mul_u32_u24 v20, 5, v20
  v_lshrrev_b32 v22, v20, v22
  v_and_b32 v22, 31, v22
  v_lshl_add_u32 v101, v22, 4, s44
  v_lshl_add_u32 v99, v22, 6, v29
PLU:
  v_bfe_u32 v16, v0, 5, 2
  v_lshrrev_b32 v17, 7, v0
  v_add_u32 v17, s45, v17
  v_lshrrev_b32 v18, 1, v17
  v_mul_u32_u24 v19, 20, v16
  v_add3_u32 v19, v19, v18, 60
  v_lshrrev_b32 v20, 1, v16
  v_lshl_add_u32 v20, v18, 1, v20
  v_and_b32 v16, 1, v16
  v_cmp_eq_u32 vcc, 1, v16
  s_nop 1
  v_cndmask_b32 v19, v20, v19, vcc
  v_cndmask_b32 v16, 2, 1, vcc
  v_and_b32 v17, 1, v17
  v_lshl_add_u32 v19, v19, 1, v17
  v_and_b32 v30, 31, v0
  v_lshl_add_u32 v19, v19, 5, v30
  s_mul_i32 s30, s17, 163840
  s_add_u32 s30, s30, 1835008
  v_lshl_add_u32 v120, v19, 4, s30
  v_lshl_add_u32 v121, v16, 10, v120
  v_lshl_add_u32 v122, v16, 10, v121
  v_lshlrev_b32 v123, 4, v0
  v_lshrrev_b32 v16, 5, v0
  v_add_u32 v17, 156, v16
  v_cmp_le_u32 vcc, 4, v16
  s_nop 1
  v_cndmask_b32 v17, v16, v17, vcc
  v_cndmask_b32 v18, 4, 3, vcc
  v_lshlrev_b32 v18, 10, v18
  s_mul_i32 s30, s17, 286720
  s_add_u32 s30, s30, 5275648
  v_lshl_add_u32 v17, v17, 6, v30
  v_lshl_add_u32 v17, v17, 4, s30
  v_cmp_eq_u32 vcc, 7, v16
  v_mov_b32 v31, 0x70000000
  s_nop 0
  v_cndmask_b32 v17, v17, v31, vcc
  s_add_u32 s30, s45, 0
  s_lshr_b32 s31, s30, 1
  s_and_b32 s30, s30, 1
  s_lshl_b32 s30, s30, 9
  v_mad_u32_u24 v124, v18, s31, v17
  v_add_u32 v124, s30, v124
  s_add_u32 s30, s45, 1
  s_lshr_b32 s31, s30, 1
  s_and_b32 s30, s30, 1
  s_lshl_b32 s30, s30, 9
  v_mad_u32_u24 v125, v18, s31, v17
  v_add_u32 v125, s30, v125
  s_add_u32 s30, s45, 2
  s_lshr_b32 s31, s30, 1
  s_and_b32 s30, s30, 1
  s_lshl_b32 s30, s30, 9
  v_mad_u32_u24 v126, v18, s31, v17
  v_add_u32 v126, s30, v126
  s_add_u32 s30, s45, 3
  s_lshr_b32 s31, s30, 1
  s_and_b32 s30, s30, 1
  s_lshl_b32 s30, s30, 9
  v_mad_u32_u24 v127, v18, s31, v17
  v_add_u32 v127, s30, v127
  s_add_u32 s30, s45, 4
  s_lshr_b32 s31, s30, 1
  s_and_b32 s30, s30, 1
  s_lshl_b32 s30, s30, 9
  v_mad_u32_u24 v128, v18, s31, v17
  v_add_u32 v128, s30, v128
  v_mul_u32_u24 v16, 205, v0
  v_lshrrev_b32 v16, 14, v16
  v_mul_u32_u24 v17, 80, v16
  v_sub_u32 v17, v0, v17
  v_lshrrev_b32 v18, 4, v17
  v_and_b32 v17, 15, v17
  v_lshlrev_b32 v17, 4, v17
  v_lshl_add_u32 v17, v18, 10, v17
  s_lshl_b32 s30, s16, 1
  s_add_u32 s30, s30, s21
  v_lshl_add_u32 v18, v16, 5, s30
  v_cmp_eq_u32 vcc, 3, v16
  v_mov_b32 v19, 400
  s_nop 0
  v_cndmask_b32 v18, v18, v19, vcc
  s_and_b32 s30, s30, 3
  s_lshl_b32 s30, s30, 8
  s_mul_i32 s31, s20, 102400
  s_add_u32 s31, s31, s30
  s_add_u32 s31, s31, 4456448
  v_add_u32 v19, s31, v17
  s_mul_i32 s31, s20, 276480
  s_add_u32 s31, s31, s30
  s_add_u32 s31, s31, 9760768
  v_add_u32 v20, s31, v17
  v_cmp_le_u32 vcc, 80, v18
  s_nop 1
  v_cndmask_b32 v21, v19, v20, vcc
  v_lshrrev_b32 v22, 2, v18
  v_mul_u32_u24 v22, 5120, v22
  v_add_u32 v21, v21, v22
  v_cmp_le_u32 vcc, 296, v18
  s_nop 1
  v_cndmask_b32 v129, v21, v31, vcc
  v_add_u32 v18, 96, v18
  v_cmp_le_u32 vcc, 80, v18
  s_nop 1
  v_cndmask_b32 v21, v19, v20, vcc
  v_lshrrev_b32 v22, 2, v18
  v_mul_u32_u24 v22, 5120, v22
  v_add_u32 v21, v21, v22
  v_cmp_le_u32 vcc, 296, v18
  s_nop 1
  v_cndmask_b32 v130, v21, v31, vcc
  v_add_u32 v18, 96, v18
  v_cmp_le_u32 vcc, 80, v18
  s_nop 1
  v_cndmask_b32 v21, v19, v20, vcc
  v_lshrrev_b32 v22, 2, v18
  v_mul_u32_u24 v22, 5120, v22
  v_add_u32 v21, v21, v22
  v_cmp_le_u32 vcc, 296, v18
  s_nop 1
  v_cndmask_b32 v131, v21, v31, vcc
  v_add_u32 v18, 96, v18
  v_cmp_le_u32 vcc, 80, v18
  s_nop 1
  v_cndmask_b32 v21, v19, v20, vcc
  v_lshrrev_b32 v22, 2, v18
  v_mul_u32_u24 v22, 5120, v22
  v_add_u32 v21, v21, v22
  v_cmp_le_u32 vcc, 296, v18
  s_nop 1
  v_cndmask_b32 v132, v21, v31, vcc
  v_add_u32 v18, 96, v18
  s_waitcnt vmcnt(0)
  buffer_load_dword v14, v4, s[84:87], 0 offen sc1
  s_cmp_eq_u32 s18, 3
  s_cbranch_scc1 PX2
  v_cmp_gt_u32 vcc, 75, v0
  s_and_b64 exec, exec, vcc
  s_cbranch_execz PB1
  v_mov_b32 v20, 0
  v_mov_b32 v21, 0
  v_mov_b32 v22, 0
  v_mov_b32 v23, 0
  v_mov_b32 v24, 0
  v_mov_b32 v25, 0
  v_mov_b32 v26, 0
  v_mov_b32 v27, 0
  v_perm_b32 v64, v36, v32, s28
  v_perm_b32 v65, v44, v40, s28
  v_perm_b32 v66, v52, v48, s28
  v_perm_b32 v67, v60, v56, s28
  ds_write_b128 v98, v[64:67] offset:0
  v_perm_b32 v68, v36, v32, s29
  v_perm_b32 v69, v44, v40, s29
  v_perm_b32 v70, v52, v48, s29
  v_perm_b32 v71, v60, v56, s29
  ds_write_b128 v98, v[68:71] offset:16
  v_perm_b32 v72, v37, v33, s28
  v_perm_b32 v73, v45, v41, s28
  v_perm_b32 v74, v53, v49, s28
  v_perm_b32 v75, v61, v57, s28
  ds_write_b128 v98, v[72:75] offset:32
  v_perm_b32 v76, v37, v33, s29
  v_perm_b32 v77, v45, v41, s29
  v_perm_b32 v78, v53, v49, s29
  v_perm_b32 v79, v61, v57, s29
  ds_write_b128 v98, v[76:79] offset:48
  v_perm_b32 v80, v38, v34, s28
  v_perm_b32 v81, v46, v42, s28
  v_perm_b32 v82, v54, v50, s28
  v_perm_b32 v83, v62, v58, s28
  ds_write_b128 v99, v[80:83] offset:0
  v_perm_b32 v84, v38, v34, s29
  v_perm_b32 v85, v46, v42, s29
  v_perm_b32 v86, v54, v50, s29
  v_perm_b32 v87, v62, v58, s29
  ds_write_b128 v99, v[84:87] offset:16
  v_perm_b32 v88, v39, v35, s28
  v_perm_b32 v89, v47, v43, s28
  v_perm_b32 v90, v55, v51, s28
  v_perm_b32 v91, v63, v59, s28
  ds_write_b128 v99, v[88:91] offset:32
  v_perm_b32 v92, v39, v35, s29
  v_perm_b32 v93, v47, v43, s29
  v_perm_b32 v94, v55, v51, s29
  v_perm_b32 v95, v63, v59, s29
  ds_write_b128 v99, v[92:95] offset:48
  v_dot2c_f32_bf16 v20, s27, v64
  v_dot2c_f32_bf16 v21, s27, v68
  v_dot2c_f32_bf16 v22, s27, v72
  v_dot2c_f32_bf16 v23, s27, v76
  v_dot2c_f32_bf16 v24, s27, v80
  v_dot2c_f32_bf16 v25, s27, v84
  v_dot2c_f32_bf16 v26, s27, v88
  v_dot2c_f32_bf16 v27, s27, v92
  v_dot2c_f32_bf16 v20, s27, v65
  v_dot2c_f32_bf16 v21, s27, v69
  v_dot2c_f32_bf16 v22, s27, v73
  v_dot2c_f32_bf16 v23, s27, v77
  v_dot2c_f32_bf16 v24, s27, v81
  v_dot2c_f32_bf16 v25, s27, v85
  v_dot2c_f32_bf16 v26, s27, v89
  v_dot2c_f32_bf16 v27, s27, v93
  v_dot2c_f32_bf16 v20, s27, v66
  v_dot2c_f32_bf16 v21, s27, v70
  v_dot2c_f32_bf16 v22, s27, v74
  v_dot2c_f32_bf16 v23, s27, v78
  v_dot2c_f32_bf16 v24, s27, v82
  v_dot2c_f32_bf16 v25, s27, v86
  v_dot2c_f32_bf16 v26, s27, v90
  v_dot2c_f32_bf16 v27, s27, v94
  v_dot2c_f32_bf16 v20, s27, v67
  v_dot2c_f32_bf16 v21, s27, v71
  v_dot2c_f32_bf16 v22, s27, v75
  v_dot2c_f32_bf16 v23, s27, v79
  v_dot2c_f32_bf16 v24, s27, v83
  v_dot2c_f32_bf16 v25, s27, v87
  v_dot2c_f32_bf16 v26, s27, v91
  v_dot2c_f32_bf16 v27, s27, v95
  ds_write_b128 v28, v[20:23] offset:0
  s_nop 1
  ds_write_b128 v28, v[24:27] offset:16
  s_branch PB1
PX2:
  v_mov_b32 v20, 0
  v_mov_b32 v21, 0
  buffer_store_dwordx4 v[32:35], v98, s[8:11], s46 offen offset:0 sc1
  v_dot2c_f32_bf16 v20, s27, v32
  v_dot2c_f32_bf16 v21, v32, v32
  v_dot2c_f32_bf16 v20, s27, v33
  v_dot2c_f32_bf16 v21, v33, v33
  v_dot2c_f32_bf16 v20, s27, v34
  v_dot2c_f32_bf16 v21, v34, v34
  v_dot2c_f32_bf16 v20, s27, v35
  v_dot2c_f32_bf16 v21, v35, v35
  buffer_store_dwordx4 v[36:39], v98, s[8:11], s46 offen offset:512 sc1
  v_dot2c_f32_bf16 v20, s27, v36
  v_dot2c_f32_bf16 v21, v36, v36
  v_dot2c_f32_bf16 v20, s27, v37
  v_dot2c_f32_bf16 v21, v37, v37
  v_dot2c_f32_bf16 v20, s27, v38
  v_dot2c_f32_bf16 v21, v38, v38
  v_dot2c_f32_bf16 v20, s27, v39
  v_dot2c_f32_bf16 v21, v39, v39
  buffer_store_dwordx4 v[40:43], v98, s[8:11], s46 offen offset:1024 sc1
  v_dot2c_f32_bf16 v20, s27, v40
  v_dot2c_f32_bf16 v21, v40, v40
  v_dot2c_f32_bf16 v20, s27, v41
  v_dot2c_f32_bf16 v21, v41, v41
  v_dot2c_f32_bf16 v20, s27, v42
  v_dot2c_f32_bf16 v21, v42, v42
  v_dot2c_f32_bf16 v20, s27, v43
  v_dot2c_f32_bf16 v21, v43, v43
  buffer_store_dwordx4 v[44:47], v98, s[8:11], s46 offen offset:1536 sc1
  v_dot2c_f32_bf16 v20, s27, v44
  v_dot2c_f32_bf16 v21, v44, v44
  v_dot2c_f32_bf16 v20, s27, v45
  v_dot2c_f32_bf16 v21, v45, v45
  v_dot2c_f32_bf16 v20, s27, v46
  v_dot2c_f32_bf16 v21, v46, v46
  v_dot2c_f32_bf16 v20, s27, v47
  v_dot2c_f32_bf16 v21, v47, v47
  buffer_store_dwordx4 v[48:51], v98, s[8:11], s46 offen offset:2048 sc1
  v_dot2c_f32_bf16 v20, s27, v48
  v_dot2c_f32_bf16 v21, v48, v48
  v_dot2c_f32_bf16 v20, s27, v49
  v_dot2c_f32_bf16 v21, v49, v49
  v_dot2c_f32_bf16 v20, s27, v50
  v_dot2c_f32_bf16 v21, v50, v50
  v_dot2c_f32_bf16 v20, s27, v51
  v_dot2c_f32_bf16 v21, v51, v51
  buffer_store_dwordx4 v[52:55], v98, s[8:11], s47 offen offset:0 sc1
  v_dot2c_f32_bf16 v20, s27, v52
  v_dot2c_f32_bf16 v21, v52, v52
  v_dot2c_f32_bf16 v20, s27, v53
  v_dot2c_f32_bf16 v21, v53, v53
  v_dot2c_f32_bf16 v20, s27, v54
  v_dot2c_f32_bf16 v21, v54, v54
  v_dot2c_f32_bf16 v20, s27, v55
  v_dot2c_f32_bf16 v21, v55, v55
  buffer_store_dwordx4 v[56:59], v98, s[8:11], s47 offen offset:512 sc1
  v_dot2c_f32_bf16 v20, s27, v56
  v_dot2c_f32_bf16 v21, v56, v56
  v_dot2c_f32_bf16 v20, s27, v57
  v_dot2c_f32_bf16 v21, v57, v57
  v_dot2c_f32_bf16 v20, s27, v58
  v_dot2c_f32_bf16 v21, v58, v58
  v_dot2c_f32_bf16 v20, s27, v59
  v_dot2c_f32_bf16 v21, v59, v59
  buffer_store_dwordx4 v[60:63], v98, s[8:11], s47 offen offset:1024 sc1
  v_dot2c_f32_bf16 v20, s27, v60
  v_dot2c_f32_bf16 v21, v60, v60
  v_dot2c_f32_bf16 v20, s27, v61
  v_dot2c_f32_bf16 v21, v61, v61
  v_dot2c_f32_bf16 v20, s27, v62
  v_dot2c_f32_bf16 v21, v62, v62
  v_dot2c_f32_bf16 v20, s27, v63
  v_dot2c_f32_bf16 v21, v63, v63
  buffer_store_dwordx4 v[64:67], v98, s[8:11], s47 offen offset:1536 sc1
  v_dot2c_f32_bf16 v20, s27, v64
  v_dot2c_f32_bf16 v21, v64, v64
  v_dot2c_f32_bf16 v20, s27, v65
  v_dot2c_f32_bf16 v21, v65, v65
  v_dot2c_f32_bf16 v20, s27, v66
  v_dot2c_f32_bf16 v21, v66, v66
  v_dot2c_f32_bf16 v20, s27, v67
  v_dot2c_f32_bf16 v21, v67, v67
  buffer_store_dwordx4 v[68:71], v98, s[8:11], s47 offen offset:2048 sc1
  v_dot2c_f32_bf16 v20, s27, v68
  v_dot2c_f32_bf16 v21, v68, v68
  v_dot2c_f32_bf16 v20, s27, v69
  v_dot2c_f32_bf16 v21, v69, v69
  v_dot2c_f32_bf16 v20, s27, v70
  v_dot2c_f32_bf16 v21, v70, v70
  v_dot2c_f32_bf16 v20, s27, v71
  v_dot2c_f32_bf16 v21, v71, v71
  s_nop 2
  buffer_store_dwordx2 v[20:21], v99, s[8:11], s48 offen sc1
PB1:
  s_mov_b64 exec, -1
  buffer_load_dwordx4 v[110:113], v12, s[80:83], s89 offen
  buffer_load_dwordx4 v[114:117], v12, s[80:83], s89 offen offset:64
  buffer_load_dwordx2 v[118:119], v13, s[80:83], s89 offen offset:128
  s_mov_b32 s36, s72
  s_mov_b32 s37, s73
  s_mov_b32 s38, 2211840
  s_mov_b32 s39, 0x20000
  v_cmp_eq_u32 vcc, 0, v108
  s_mov_b64 exec, vcc
  s_cbranch_execz PL0
  s_mov_b32 s33, 3456
  s_mov_b32 s34, 6912
  s_mov_b32 s35, 10368
  buffer_load_dwordx4 v[136:139], v102, s[36:39], 0 offen
  buffer_load_dwordx4 v[140:143], v102, s[36:39], s33 offen
  buffer_load_dwordx4 v[144:147], v102, s[36:39], s34 offen
  buffer_load_dwordx4 v[148:151], v102, s[36:39], s35 offen
  buffer_load_dwordx4 v[152:155], v103, s[36:39], 0 offen
  buffer_load_dwordx4 v[156:159], v103, s[36:39], s33 offen
  buffer_load_dwordx4 v[160:163], v103, s[36:39], s34 offen
  buffer_load_dwordx4 v[164:167], v103, s[36:39], s35 offen
PL0:
  s_mov_b64 exec, -1
  s_mov_b32 s36, s74
  s_mov_b32 s37, s75
  s_mov_b32 s38, 2211840
  s_mov_b32 s39, 0x20000
  v_cmp_eq_u32 vcc, 1, v108
  s_mov_b64 exec, vcc
  s_cbranch_execz PL1
  s_mov_b32 s33, 3456
  s_mov_b32 s34, 6912
  s_mov_b32 s35, 10368
  buffer_load_dwordx4 v[136:139], v102, s[36:39], 0 offen
  buffer_load_dwordx4 v[140:143], v102, s[36:39], s33 offen
  buffer_load_dwordx4 v[144:147], v102, s[36:39], s34 offen
  buffer_load_dwordx4 v[148:151], v102, s[36:39], s35 offen
  buffer_load_dwordx4 v[152:155], v103, s[36:39], 0 offen
  buffer_load_dwordx4 v[156:159], v103, s[36:39], s33 offen
  buffer_load_dwordx4 v[160:163], v103, s[36:39], s34 offen
  buffer_load_dwordx4 v[164:167], v103, s[36:39], s35 offen
PL1:
  s_mov_b64 exec, -1
  s_mov_b32 s36, s68
  s_mov_b32 s37, s69
  s_mov_b32 s38, 819200
  s_mov_b32 s39, 0x20000
  v_cmp_eq_u32 vcc, 2, v108
  s_mov_b64 exec, vcc
  s_cbranch_execz PL2
  s_mov_b32 s33, 1280
  s_mov_b32 s34, 2560
  s_mov_b32 s35, 3840
  buffer_load_dwordx4 v[136:139], v102, s[36:39], 0 offen
  buffer_load_dwordx4 v[140:143], v102, s[36:39], s33 offen
  buffer_load_dwordx4 v[144:147], v102, s[36:39], s34 offen
  buffer_load_dwordx4 v[148:151], v102, s[36:39], s35 offen
  buffer_load_dwordx4 v[152:155], v103, s[36:39], 0 offen
  buffer_load_dwordx4 v[156:159], v103, s[36:39], s33 offen
  buffer_load_dwordx4 v[160:163], v103, s[36:39], s34 offen
  buffer_load_dwordx4 v[164:167], v103, s[36:39], s35 offen
PL2:
  s_mov_b64 exec, -1
  s_mov_b32 s36, s76
  s_mov_b32 s37, s77
  s_mov_b32 s38, 2211840
  s_mov_b32 s39, 0x20000
  v_cmp_eq_u32 vcc, 3, v108
  s_mov_b64 exec, vcc
  s_cbranch_execz PL3
  s_mov_b32 s33, 1280
  s_mov_b32 s34, 2560
  s_mov_b32 s35, 3840
  buffer_load_dwordx4 v[136:139], v102, s[36:39], 0 offen
  buffer_load_dwordx4 v[140:143], v102, s[36:39], s33 offen
  buffer_load_dwordx4 v[144:147], v102, s[36:39], s34 offen
  buffer_load_dwordx4 v[148:151], v102, s[36:39], s35 offen
  buffer_load_dwordx4 v[152:155], v103, s[36:39], 0 offen
  buffer_load_dwordx4 v[156:159], v103, s[36:39], s33 offen
  buffer_load_dwordx4 v[160:163], v103, s[36:39], s34 offen
  buffer_load_dwordx4 v[164:167], v103, s[36:39], s35 offen
PL3:
  s_mov_b64 exec, -1
  s_waitcnt lgkmcnt(0)
  s_barrier
  v_cmp_le_u32 vcc, 128, v0
  s_nop 1
  v_cndmask_b32 v122, v122, v31, vcc
  ds_read_b128 v[168:171], v123 offset:16384
  ds_read_b128 v[172:175], v123 offset:20480
  ds_read_b128 v[176:179], v123 offset:24576
  s_waitcnt lgkmcnt(2)
  buffer_store_dwordx4 v[168:171], v120, s[8:11], 0 offen sc1
  s_waitcnt lgkmcnt(1)
  buffer_store_dwordx4 v[172:175], v121, s[8:11], 0 offen sc1
  s_waitcnt lgkmcnt(0)
  buffer_store_dwordx4 v[176:179], v122, s[8:11], 0 offen sc1
  v_cmp_gt_u32 vcc, 15, v0
  s_and_b64 exec, exec, vcc
  s_cbranch_execz PC1
  ds_read_b128 v[64:67], v28 offset:480
  ds_read_b128 v[68:71], v28 offset:496
  ds_read_b128 v[72:75], v28 offset:960
  ds_read_b128 v[76:79], v28 offset:976
  ds_read_b128 v[80:83], v28 offset:1440
  ds_read_b128 v[84:87], v28 offset:1456
  ds_read_b128 v[88:91], v28 offset:1920
  ds_read_b128 v[92:95], v28 offset:1936
  s_waitcnt lgkmcnt(0)
  v_pk_add_f32 v[20:21], v[20:21], v[64:65]
  v_pk_add_f32 v[22:23], v[22:23], v[66:67]
  v_pk_add_f32 v[24:25], v[24:25], v[68:69]
  v_pk_add_f32 v[26:27], v[26:27], v[70:71]
  v_pk_add_f32 v[20:21], v[20:21], v[72:73]
  v_pk_add_f32 v[22:23], v[22:23], v[74:75]
  v_pk_add_f32 v[24:25], v[24:25], v[76:77]
  v_pk_add_f32 v[26:27], v[26:27], v[78:79]
  v_pk_add_f32 v[20:21], v[20:21], v[80:81]
  v_pk_add_f32 v[22:23], v[22:23], v[82:83]
  v_pk_add_f32 v[24:25], v[24:25], v[84:85]
  v_pk_add_f32 v[26:27], v[26:27], v[86:87]
  v_pk_add_f32 v[20:21], v[20:21], v[88:89]
  v_pk_add_f32 v[22:23], v[22:23], v[90:91]
  v_pk_add_f32 v[24:25], v[24:25], v[92:93]
  v_pk_add_f32 v[26:27], v[26:27], v[94:95]
  buffer_store_dwordx4 v[20:23], v100, s[8:11], 0 offen sc1
  buffer_store_dwordx4 v[24:27], v101, s[8:11], 0 offen sc1
PC1:
  s_mov_b64 exec, -1
  s_waitcnt vmcnt(5)
  s_cmp_eq_u32 s18, 0
  s_cbranch_scc1 PW2
  s_waitcnt vmcnt(3)
PW2:
  v_cmp_gt_u32 vcc, 4, v108
  s_mov_b64 exec, vcc
  s_cbranch_execz PB2
  v_mov_b32 v20, 0
  v_mov_b32 v21, 0
  v_mov_b32 v22, 0
  v_mov_b32 v23, 0
  v_mov_b32 v24, 0
  v_mov_b32 v25, 0
  v_mov_b32 v26, 0
  v_mov_b32 v27, 0
  v_perm_b32 v64, v140, v136, s28
  v_perm_b32 v65, v148, v144, s28
  v_perm_b32 v66, v156, v152, s28
  v_perm_b32 v67, v164, v160, s28
  ds_write_b128 v104, v[64:67] offset:0
  v_perm_b32 v68, v140, v136, s29
  v_perm_b32 v69, v148, v144, s29
  v_perm_b32 v70, v156, v152, s29
  v_perm_b32 v71, v164, v160, s29
  ds_write_b128 v104, v[68:71] offset:16
  v_perm_b32 v72, v141, v137, s28
  v_perm_b32 v73, v149, v145, s28
  v_perm_b32 v74, v157, v153, s28
  v_perm_b32 v75, v165, v161, s28
  ds_write_b128 v104, v[72:75] offset:32
  v_perm_b32 v76, v141, v137, s29
  v_perm_b32 v77, v149, v145, s29
  v_perm_b32 v78, v157, v153, s29
  v_perm_b32 v79, v165, v161, s29
  ds_write_b128 v104, v[76:79] offset:48
  v_perm_b32 v80, v142, v138, s28
  v_perm_b32 v81, v150, v146, s28
  v_perm_b32 v82, v158, v154, s28
  v_perm_b32 v83, v166, v162, s28
  ds_write_b128 v105, v[80:83] offset:0
  v_perm_b32 v84, v142, v138, s29
  v_perm_b32 v85, v150, v146, s29
  v_perm_b32 v86, v158, v154, s29
  v_perm_b32 v87, v166, v162, s29
  ds_write_b128 v105, v[84:87] offset:16
  v_perm_b32 v88, v143, v139, s28
  v_perm_b32 v89, v151, v147, s28
  v_perm_b32 v90, v159, v155, s28
  v_perm_b32 v91, v167, v163, s28
  ds_write_b128 v105, v[88:91] offset:32
  v_perm_b32 v92, v143, v139, s29
  v_perm_b32 v93, v151, v147, s29
  v_perm_b32 v94, v159, v155, s29
  v_perm_b32 v95, v167, v163, s29
  ds_write_b128 v105, v[92:95] offset:48
  v_dot2c_f32_bf16 v20, s27, v64
  v_dot2c_f32_bf16 v21, s27, v68
  v_dot2c_f32_bf16 v22, s27, v72
  v_dot2c_f32_bf16 v23, s27, v76
  v_dot2c_f32_bf16 v24, s27, v80
  v_dot2c_f32_bf16 v25, s27, v84
  v_dot2c_f32_bf16 v26, s27, v88
  v_dot2c_f32_bf16 v27, s27, v92
  v_dot2c_f32_bf16 v20, s27, v65
  v_dot2c_f32_bf16 v21, s27, v69
  v_dot2c_f32_bf16 v22, s27, v73
  v_dot2c_f32_bf16 v23, s27, v77
  v_dot2c_f32_bf16 v24, s27, v81
  v_dot2c_f32_bf16 v25, s27, v85
  v_dot2c_f32_bf16 v26, s27, v89
  v_dot2c_f32_bf16 v27, s27, v93
  v_dot2c_f32_bf16 v20, s27, v66
  v_dot2c_f32_bf16 v21, s27, v70
  v_dot2c_f32_bf16 v22, s27, v74
  v_dot2c_f32_bf16 v23, s27, v78
  v_dot2c_f32_bf16 v24, s27, v82
  v_dot2c_f32_bf16 v25, s27, v86
  v_dot2c_f32_bf16 v26, s27, v90
  v_dot2c_f32_bf16 v27, s27, v94
  v_dot2c_f32_bf16 v20, s27, v67
  v_dot2c_f32_bf16 v21, s27, v71
  v_dot2c_f32_bf16 v22, s27, v75
  v_dot2c_f32_bf16 v23, s27, v79
  v_dot2c_f32_bf16 v24, s27, v83
  v_dot2c_f32_bf16 v25, s27, v87
  v_dot2c_f32_bf16 v26, s27, v91
  v_dot2c_f32_bf16 v27, s27, v95
  ds_write_b128 v28, v[20:23] offset:4096
  s_nop 1
  ds_write_b128 v28, v[24:27] offset:4112
PB2:
  s_mov_b64 exec, -1
  s_mov_b32 s32, 0x40000
  s_branch L_nc
L_nw:
  buffer_load_dword v14, v4, s[84:87], 0 offen sc1
  s_sub_u32 s32, s32, 1
  s_cbranch_scc1 L_nd
L_nc:
  s_waitcnt vmcnt(0)
  v_readfirstlane_b32 s25, v14
  s_cmp_eq_u32 s25, 0
  s_cbranch_scc1 L_nw
L_nd:
  s_waitcnt lgkmcnt(0)
  s_barrier
  s_cmp_lg_u32 s18, 0
  s_cbranch_scc1 PF1
  s_lshl_b32 s30, s16, 13
  s_lshl_b32 s31, s17, 9
  s_add_u32 s30, s30, s31
  s_add_u32 s30, s30, 12075008
  v_mov_b32 v14, s25
  s_mov_b64 exec, 1
  buffer_store_dword v14, v4, s[8:11], s30 offen sc1
  s_mov_b64 exec, -1
PF1:
  ds_read_b128 v[164:167], v123 offset:32768
  ds_read_b128 v[168:171], v123 offset:36352
  ds_read_b128 v[172:175], v123 offset:39936
  ds_read_b128 v[176:179], v123 offset:43520
  ds_read_b128 v[180:183], v123 offset:47104
  ds_read_b128 v[184:187], v123 offset:51200
  ds_read_b128 v[188:191], v123 offset:55040
  ds_read_b128 v[192:195], v123 offset:58880
  ds_read_b128 v[196:199], v123 offset:62720
  v_mov_b32 v200, v124
  v_mov_b32 v201, v125
  v_mov_b32 v202, v126
  v_mov_b32 v203, v127
  v_mov_b32 v204, v128
  v_mov_b32 v205, v129
  v_mov_b32 v206, v130
  v_mov_b32 v207, v131
  v_mov_b32 v208, v132
  v_cmp_gt_u32 vcc, 4, v108
  v_cmp_eq_u32 s[30:31], 0, v109
  s_and_b64 exec, vcc, s[30:31]
  s_cbranch_execz PC2
  ds_read_b128 v[64:67], v28 offset:4544
  ds_read_b128 v[68:71], v28 offset:4560
  ds_read_b128 v[72:75], v28 offset:4992
  ds_read_b128 v[76:79], v28 offset:5008
  ds_read_b128 v[80:83], v28 offset:5440
  ds_read_b128 v[84:87], v28 offset:5456
  ds_read_b128 v[88:91], v28 offset:5888
  ds_read_b128 v[92:95], v28 offset:5904
  s_waitcnt lgkmcnt(0)
  v_pk_add_f32 v[20:21], v[20:21], v[64:65]
  v_pk_add_f32 v[22:23], v[22:23], v[66:67]
  v_pk_add_f32 v[24:25], v[24:25], v[68:69]
  v_pk_add_f32 v[26:27], v[26:27], v[70:71]
  v_pk_add_f32 v[20:21], v[20:21], v[72:73]
  v_pk_add_f32 v[22:23], v[22:23], v[74:75]
  v_pk_add_f32 v[24:25], v[24:25], v[76:77]
  v_pk_add_f32 v[26:27], v[26:27], v[78:79]
  v_pk_add_f32 v[20:21], v[20:21], v[80:81]
  v_pk_add_f32 v[22:23], v[22:23], v[82:83]
  v_pk_add_f32 v[24:25], v[24:25], v[84:85]
  v_pk_add_f32 v[26:27], v[26:27], v[86:87]
  v_pk_add_f32 v[20:21], v[20:21], v[88:89]
  v_pk_add_f32 v[22:23], v[22:23], v[90:91]
  v_pk_add_f32 v[24:25], v[24:25], v[92:93]
  v_pk_add_f32 v[26:27], v[26:27], v[94:95]
  buffer_store_dwordx4 v[20:23], v106, s[8:11], 0 offen sc1
  buffer_store_dwordx4 v[24:27], v107, s[8:11], 0 offen sc1
PC2:
  s_mov_b64 exec, -1
  s_waitcnt lgkmcnt(0)
  s_lshl_b32 s30, s16, 4
  s_lshl_b32 s31, s18, 2
  s_add_u32 s30, s30, s31
  s_sub_u32 s30, s30, 16
  v_lshl_add_u32 v225, v5, 4, s17
  v_add_u32 v224, s30, v5
  v_cmp_gt_u32 vcc, 16, v5
  s_nop 1
  v_cndmask_b32 v225, v224, v225, vcc
  v_lshlrev_b32 v225, 9, v225
  s_mov_b32 s24, 12075008
  v_mov_b32 v224, s25
  s_mov_b64 exec, 0xfffff
  buffer_load_dword v224, v225, s[8:11], s24 offen sc1
  s_mov_b64 exec, -1
  v_and_b32 v14, 31, v5
  v_lshrrev_b32 v15, 4, v6
  v_sub_u32 v14, v14, v15
  v_cmp_le_i32 s[56:57], 0, v14
  v_cmp_le_i32 s[58:59], 1, v14
  v_cmp_le_i32 s[60:61], 2, v14
  v_cmp_le_i32 s[62:63], 3, v14
  v_cmp_le_i32 s[64:65], 8, v14
  v_cmp_le_i32 s[66:67], 9, v14
  v_cmp_le_i32 s[68:69], 10, v14
  v_cmp_le_i32 s[70:71], 11, v14
  v_cmp_le_i32 s[72:73], 16, v14
  v_cmp_le_i32 s[74:75], 17, v14
  v_cmp_le_i32 s[76:77], 18, v14
  v_cmp_le_i32 s[78:79], 19, v14
  v_cmp_le_i32 s[80:81], 24, v14
  v_cmp_le_i32 s[82:83], 25, v14
  v_cmp_le_i32 s[84:85], 26, v14
  v_cmp_le_i32 s[86:87], 27, v14
  s_waitcnt vmcnt(0)
  v_cmp_ne_u32 vcc, s25, v224
  s_cbranch_vccz PL_1_k
  s_mov_b32 s32, 0x40000
  s_mov_b64 exec, 0xfffff
PL_1_p:
  buffer_load_dword v224, v225, s[8:11], s24 offen sc1
  s_sub_u32 s32, s32, 1
  s_cbranch_scc1 PL_1_d
  s_waitcnt vmcnt(0)
  v_cmp_ne_u32 vcc, s25, v224
  s_cbranch_vccnz PL_1_p
PL_1_d:
  s_mov_b64 exec, -1
PL_1_k:
  s_barrier
  s_mul_i32 s30, s17, 22528
  s_lshl_b32 s31, s18, 7
  s_add_u32 s30, s30, s31
  s_add_u32 s30, s30, 12206080
  v_mul_u32_u24 v14, 176, v6
  v_and_b32 v15, 31, v5
  v_lshl_add_u32 v14, v15, 2, v14
  buffer_load_dword v32, v14, s[8:11], s30 offen offset:0 sc1
  buffer_load_dword v33, v14, s[8:11], s30 offen offset:1408 sc1
  s_add_u32 s30, s30, 2816
  buffer_load_dword v34, v14, s[8:11], s30 offen offset:0 sc1
  buffer_load_dword v35, v14, s[8:11], s30 offen offset:1408 sc1
  s_add_u32 s30, s30, 2816
  buffer_load_dword v36, v14, s[8:11], s30 offen offset:0 sc1
  buffer_load_dword v37, v14, s[8:11], s30 offen offset:1408 sc1
  s_add_u32 s30, s30, 2816
  buffer_load_dword v38, v14, s[8:11], s30 offen offset:0 sc1
  buffer_load_dword v39, v14, s[8:11], s30 offen offset:1408 sc1
  s_mul_i32 s54, s17, 163840
  s_mul_i32 s55, s18, 25600
  s_add_u32 s54, s54, s55
  s_add_u32 s28, s54, 1835008
  s_add_u32 m0, s55, 0
  s_nop 0
  buffer_load_dwordx4 v1, s[8:11], s28 offen offset:0 sc1 lds
  buffer_load_dwordx4 v1, s[8:11], s28 offen offset:1024 sc1 lds
  buffer_load_dwordx4 v1, s[8:11], s28 offen offset:2048 sc1 lds
  buffer_load_dwordx4 v1, s[8:11], s28 offen offset:3072 sc1 lds
  s_add_u32 s28, s54, 1839104
  s_add_u32 m0, s55, 4096
  s_nop 0
  buffer_load_dwordx4 v1, s[8:11], s28 offen offset:0 sc1 lds
  buffer_load_dwordx4 v1, s[8:11], s28 offen offset:1024 sc1 lds
  buffer_load_dwordx4 v1, s[8:11], s28 offen offset:2048 sc1 lds
  buffer_load_dwordx4 v1, s[8:11], s28 offen offset:3072 sc1 lds
  s_add_u32 s28, s54, 1843200
  s_add_u32 m0, s55, 8192
  s_nop 0
  buffer_load_dwordx4 v1, s[8:11], s28 offen offset:0 sc1 lds
  buffer_load_dwordx4 v1, s[8:11], s28 offen offset:1024 sc1 lds
  buffer_load_dwordx4 v1, s[8:11], s28 offen offset:2048 sc1 lds
  buffer_load_dwordx4 v1, s[8:11], s28 offen offset:3072 sc1 lds
  s_add_u32 s28, s54, 1847296
  s_add_u32 m0, s55, 12288
  s_nop 0
  buffer_load_dwordx4 v1, s[8:11], s28 offen offset:0 sc1 lds
  buffer_load_dwordx4 v1, s[8:11], s28 offen offset:1024 sc1 lds
  buffer_load_dwordx4 v1, s[8:11], s28 offen offset:2048 sc1 lds
  buffer_load_dwordx4 v1, s[8:11], s28 offen offset:3072 sc1 lds
  s_add_u32 s28, s54, 1851392
  s_add_u32 m0, s55, 16384
  s_nop 0
  buffer_load_dwordx4 v1, s[8:11], s28 offen offset:0 sc1 lds
  buffer_load_dwordx4 v1, s[8:11], s28 offen offset:1024 sc1 lds
  buffer_load_dwordx4 v1, s[8:11], s28 offen offset:2048 sc1 lds
  buffer_load_dwordx4 v1, s[8:11], s28 offen offset:3072 sc1 lds
  s_add_u32 s28, s54, 1855488
  s_add_u32 m0, s55, 20480
  s_nop 0
  buffer_load_dwordx4 v1, s[8:11], s28 offen offset:0 sc1 lds
  buffer_load_dwordx4 v1, s[8:11], s28 offen offset:1024 sc1 lds
  buffer_load_dwordx4 v1, s[8:11], s28 offen offset:2048 sc1 lds
  buffer_load_dwordx4 v1, s[8:11], s28 offen offset:3072 sc1 lds
  s_add_u32 s28, s54, 1859584
  s_add_u32 m0, s55, 24576
  s_nop 0
  buffer_load_dwordx4 v1, s[8:11], s28 offen offset:0 sc1 lds
  s_mul_i32 s54, s17, 163840
  s_mul_i32 s55, s18, 5120
  s_add_u32 s54, s54, s55
  v_lshlrev_b32 v236, 16, v110
  v_and_b32 v237, 0xffff0000, v110
  v_lshlrev_b32 v238, 16, v111
  v_and_b32 v239, 0xffff0000, v111
  v_lshlrev_b32 v240, 16, v112
  v_and_b32 v241, 0xffff0000, v112
  v_lshlrev_b32 v242, 16, v113
  v_and_b32 v243, 0xffff0000, v113
  v_lshlrev_b32 v244, 16, v114
  v_and_b32 v245, 0xffff0000, v114
  v_lshlrev_b32 v246, 16, v115
  v_and_b32 v247, 0xffff0000, v115
  v_lshlrev_b32 v248, 16, v116
  v_and_b32 v249, 0xffff0000, v116
  v_lshlrev_b32 v250, 16, v117
  v_and_b32 v251, 0xffff0000, v117
  v_lshlrev_b32 v252, 16, v118
  v_and_b32 v253, 0xffff0000, v118
  v_lshlrev_b32 v254, 16, v119
  v_and_b32 v255, 0xffff0000, v119
  s_waitcnt vmcnt(25)
  v_pk_add_f32 v[32:33], v[32:33], v[34:35]
  v_pk_add_f32 v[36:37], v[36:37], v[38:39]
  v_pk_add_f32 v[32:33], v[32:33], v[36:37]
  v_add_f32 v32, v32, v33
  v_mov_b32 v33, v32
  s_nop 1
  v_permlane32_swap_b32 v32, v33
  v_add_f32 v32, v32, v33
  v_cvt_pk_bf16_f32 v35, v32, v32
  v_and_b32 v33, 0xffff0000, v35
  v_sub_f32 v33, v32, v33
  v_cvt_pk_bf16_f32 v34, v32, v33
  v_and_b32 v35, 0xffff, v35
  v_lshlrev_b32 v15, 24, v6
  v_lshl_add_u32 v15, v5, 3, v15
  s_lshl_b32 s31, s18, 8
  s_add_u32 s31, s31, s88
  buffer_store_dwordx2 v[34:35], v15, s[8:11], s31 offen offset:0
  s_add_u32 s28, s54, 1937408
  s_add_u32 m0, s55, 102400
  s_nop 0
  buffer_load_dwordx4 v1, s[8:11], s28 offen offset:0 sc1 lds
  buffer_load_dwordx4 v1, s[8:11], s28 offen offset:1024 sc1 lds
  buffer_load_dwordx4 v1, s[8:11], s28 offen offset:2048 sc1 lds
  buffer_load_dwordx4 v1, s[8:11], s28 offen offset:3072 sc1 lds
  s_add_u32 s28, s54, 1941504
  s_add_u32 m0, s55, 106496
  s_nop 0
  buffer_load_dwordx4 v1, s[8:11], s28 offen offset:0 sc1 lds
L_layer:
  s_lshl_b32 s35, s19, 1
  s_add_u32 s35, s35, 0
  s_mul_i32 s33, s35, 2621440
  s_lshl_b32 s34, s16, 2
  s_add_u32 s34, s34, s18
  s_mul_i32 s36, s34, 40960
  s_add_u32 s38, s33, s36
  s_mul_i32 s35, s35, 131072
  s_lshl_b32 s34, s34, 8
  s_add_u32 s39, s35, s34
  s_add_u32 s37, s88, 0
  s_add_u32 s29, s38, 13357056
  buffer_load_dwordx4 a[0:3], v1, s[8:11], s29 offen offset:0 sc1
  buffer_load_dwordx4 a[4:7], v1, s[8:11], s29 offen offset:1024 sc1
  buffer_load_dwordx4 a[8:11], v1, s[8:11], s29 offen offset:2048 sc1
  buffer_load_dwordx4 a[12:15], v1, s[8:11], s29 offen offset:3072 sc1
  s_add_u32 s29, s38, 13361152
  buffer_load_dwordx4 a[16:19], v1, s[8:11], s29 offen offset:0 sc1
  buffer_load_dwordx4 a[20:23], v1, s[8:11], s29 offen offset:1024 sc1
  buffer_load_dwordx4 a[24:27], v1, s[8:11], s29 offen offset:2048 sc1
  buffer_load_dwordx4 a[28:31], v1, s[8:11], s29 offen offset:3072 sc1
  s_add_u32 s29, s38, 13365248
  buffer_load_dwordx4 a[32:35], v1, s[8:11], s29 offen offset:0 sc1
  buffer_load_dwordx4 a[36:39], v1, s[8:11], s29 offen offset:1024 sc1
  buffer_load_dwordx4 a[40:43], v1, s[8:11], s29 offen offset:2048 sc1
  buffer_load_dwordx4 a[44:47], v1, s[8:11], s29 offen offset:3072 sc1
  s_waitcnt vmcnt(12)
  s_barrier
  s_mul_i32 s54, s17, 163840
  s_mul_i32 s55, s18, 10240
  s_add_u32 s54, s54, s55
  ds_read_b128 v[80:83], v1 offset:0
  ds_read_b128 v[84:87], v1 offset:1024
  ds_read_b128 v[88:91], v1 offset:2048
  ds_read_b128 v[92:95], v1 offset:3072
  ds_read_b128 v[96:99], v2 offset:16384
  ds_read_b128 v[100:103], v1 offset:4096
  s_waitcnt vmcnt(11)
  s_waitcnt lgkmcnt(4)
  v_mfma_f32_32x32x16_bf16 v[16:31], v[80:83], a[0:3], 0
  ds_read_b128 v[104:107], v1 offset:5120
  s_add_u32 s29, s38, 13369344
  buffer_load_dwordx4 a[48:51], v1, s[8:11], s29 offen offset:0 sc1
  v_mfma_f32_32x32x16_bf16 v[48:63], v[84:87], a[0:3], 0
  ds_read_b128 v[108:111], v2 offset:17408
  s_add_u32 s33, s18, 8
  s_mul_i32 s34, s33, 2560
  v_add_u32 v132, s34, v1
  s_waitcnt vmcnt(11)
  s_waitcnt lgkmcnt(4)
  v_mfma_f32_32x32x16_bf16 v[16:31], v[88:91], a[4:7], v[16:31]
  ds_read_b128 v[80:83], v1 offset:6144
  buffer_load_dwordx4 a[52:55], v1, s[8:11], s29 offen offset:1024 sc1
  v_mfma_f32_32x32x16_bf16 v[48:63], v[92:95], a[4:7], v[48:63]
  ds_read_b128 v[84:87], v1 offset:7168
  v_lshrrev_b32 v133, 1, v1
  v_add_u32 v134, s34, v133
  s_waitcnt lgkmcnt(4)
  v_mfma_f32_32x32x16_bf16 v[32:47], v[96:99], a[0:3], 0
  ds_read_b128 v[88:91], v1 offset:8192
  buffer_load_dwordx4 a[56:59], v1, s[8:11], s29 offen offset:2048 sc1
  s_waitcnt vmcnt(12)
  v_mfma_f32_32x32x16_bf16 v[16:31], v[100:103], a[8:11], v[16:31]
  ds_read_b128 v[92:95], v1 offset:9216
  s_mul_i32 s33, s33, 3072
  s_add_u32 s33, s33, 30720
  v_and_b32 v135, 31, v5
  s_waitcnt lgkmcnt(4)
  v_mfma_f32_32x32x16_bf16 v[48:63], v[104:107], a[8:11], v[48:63]
  ds_read_b128 v[96:99], v2 offset:18432
  buffer_load_dwordx4 a[60:63], v1, s[8:11], s29 offen offset:3072 sc1
  v_mfma_f32_32x32x16_bf16 v[32:47], v[108:111], a[4:7], v[32:47]
  ds_read_b128 v[100:103], v1 offset:10240
  s_add_u32 s31, s39, 23842816
  buffer_load_dwordx2 v[224:225], v7, s[8:11], s31 offen sc1
  v_mul_u32_u24 v135, 48, v135
  v_add_u32 v135, s33, v135
  s_waitcnt vmcnt(13)
  s_waitcnt lgkmcnt(4)
  v_mfma_f32_32x32x16_bf16 v[16:31], v[80:83], a[12:15], v[16:31]
  ds_read_b128 v[104:107], v1 offset:11264
  s_add_u32 s31, s39, 23859200
  buffer_load_dwordx2 v[226:227], v7, s[8:11], s31 offen sc1
  v_mfma_f32_32x32x16_bf16 v[48:63], v[84:87], a[12:15], v[48:63]
  ds_read_b128 v[108:111], v2 offset:19456
  s_add_u32 s31, s39, 23875584
  buffer_load_dwordx2 v[228:229], v7, s[8:11], s31 offen sc1
  v_lshrrev_b32 v136, 3, v6
  v_add_u32 v136, v135, v136
  v_mul_u32_u24 v137, 24, v6
  s_waitcnt vmcnt(14)
  s_waitcnt lgkmcnt(4)
  v_mfma_f32_32x32x16_bf16 v[16:31], v[88:91], a[16:19], v[16:31]
  ds_read_b128 v[80:83], v1 offset:12288
  s_add_u32 s31, s39, 23891968
  buffer_load_dwordx2 v[230:231], v7, s[8:11], s31 offen sc1
  v_mfma_f32_32x32x16_bf16 v[48:63], v[92:95], a[16:19], v[48:63]
  ds_read_b128 v[84:87], v1 offset:13312
  v_lshlrev_b32 v15, 24, v6
  v_lshl_add_u32 v15, v5, 3, v15
  buffer_load_dwordx2 v[156:157], v15, s[8:11], s37 offen offset:0 sc1
  v_add_u32 v137, v135, v137
  v_add_u32 v135, s33, v1
  s_waitcnt lgkmcnt(4)
  v_mfma_f32_32x32x16_bf16 v[32:47], v[96:99], a[8:11], v[32:47]
  ds_read_b128 v[88:91], v1 offset:14336
  buffer_load_dwordx2 v[158:159], v15, s[8:11], s37 offen offset:256 sc1
  s_waitcnt vmcnt(16)
  v_mfma_f32_32x32x16_bf16 v[16:31], v[100:103], a[20:23], v[16:31]
  ds_read_b128 v[92:95], v1 offset:15360
  buffer_load_dwordx2 v[160:161], v15, s[8:11], s37 offen offset:512 sc1
  v_mov_b32 v138, 0x3f80
  v_mov_b32 v139, 0
  s_lshl_b32 s33, s19, 4
  s_waitcnt lgkmcnt(4)
  v_mfma_f32_32x32x16_bf16 v[48:63], v[104:107], a[20:23], v[48:63]
  ds_read_b128 v[96:99], v2 offset:20480
  buffer_load_dwordx2 v[162:163], v15, s[8:11], s37 offen offset:768 sc1
  v_mfma_f32_32x32x16_bf16 v[32:47], v[108:111], a[12:15], v[32:47]
  ds_read_b128 v[100:103], v1 offset:16384
  s_add_u32 s33, s33, s17
  s_lshl_b32 s33, s33, 4
  s_waitcnt vmcnt(17)
  s_waitcnt lgkmcnt(4)
  v_mfma_f32_32x32x16_bf16 v[16:31], v[80:83], a[24:27], v[16:31]
  ds_read_b128 v[104:107], v1 offset:17408
  s_add_u32 s29, s38, 13373440
  buffer_load_dwordx4 a[64:67], v1, s[8:11], s29 offen offset:0 sc1
  v_mfma_f32_32x32x16_bf16 v[48:63], v[84:87], a[24:27], v[48:63]
  ds_read_b128 v[108:111], v2 offset:21504
  s_add_u32 s33, s33, s16
  s_lshl_b32 s33, s33, 2
  s_mul_i32 s44, s33, 2560
  s_waitcnt vmcnt(17)
  s_waitcnt lgkmcnt(4)
  v_mfma_f32_32x32x16_bf16 v[16:31], v[88:91], a[28:31], v[16:31]
  ds_read_b128 v[80:83], v1 offset:18432
  buffer_load_dwordx4 a[68:71], v1, s[8:11], s29 offen offset:1024 sc1
  v_mfma_f32_32x32x16_bf16 v[48:63], v[92:95], a[28:31], v[48:63]
  ds_read_b128 v[84:87], v1 offset:19456
  s_add_u32 s44, s44, 24367104
  s_mul_i32 s45, s33, 3072
  s_waitcnt lgkmcnt(4)
  v_mfma_f32_32x32x16_bf16 v[32:47], v[96:99], a[16:19], v[32:47]
  ds_read_b128 v[88:91], v1 offset:20480
  buffer_load_dwordx4 a[72:75], v1, s[8:11], s29 offen offset:2048 sc1
  s_waitcnt vmcnt(18)
  v_mfma_f32_32x32x16_bf16 v[16:31], v[100:103], a[32:35], v[16:31]
  ds_read_b128 v[92:95], v1 offset:21504
  s_add_u32 s45, s45, 29609984
  s_mul_i32 s46, s18, 2560
  s_add_u32 s46, s46, s44
  s_waitcnt lgkmcnt(4)
  v_mfma_f32_32x32x16_bf16 v[48:63], v[104:107], a[32:35], v[48:63]
  ds_read_b128 v[96:99], v2 offset:22528
  buffer_load_dwordx4 a[76:79], v1, s[8:11], s29 offen offset:3072 sc1
  v_mfma_f32_32x32x16_bf16 v[32:47], v[108:111], a[20:23], v[32:47]
  ds_read_b128 v[100:103], v1 offset:22528
  s_mul_i32 s47, s18, 3072
  s_add_u32 s47, s47, s45
  s_waitcnt vmcnt(18)
  s_waitcnt lgkmcnt(4)
  v_mfma_f32_32x32x16_bf16 v[16:31], v[80:83], a[36:39], v[16:31]
  ds_read_b128 v[104:107], v1 offset:23552
  s_add_u32 s29, s38, 13377536
  buffer_load_dwordx4 a[80:83], v1, s[8:11], s29 offen offset:0 sc1
  v_mfma_f32_32x32x16_bf16 v[48:63], v[84:87], a[36:39], v[48:63]
  ds_read_b128 v[108:111], v2 offset:23552
  s_mul_i32 s33, s20, 102400
  s_mul_i32 s34, s18, 25600
  s_add_u32 s48, s33, s34
  s_waitcnt vmcnt(18)
  s_waitcnt lgkmcnt(4)
  v_mfma_f32_32x32x16_bf16 v[16:31], v[88:91], a[40:43], v[16:31]
  ds_read_b128 v[80:83], v1 offset:24576
  buffer_load_dwordx4 a[84:87], v1, s[8:11], s29 offen offset:1024 sc1
  v_mfma_f32_32x32x16_bf16 v[48:63], v[92:95], a[40:43], v[48:63]
  ds_read_b128 v[84:87], v1 offset:25600
  s_waitcnt lgkmcnt(4)
  v_mfma_f32_32x32x16_bf16 v[32:47], v[96:99], a[24:27], v[32:47]
  ds_read_b128 v[88:91], v1 offset:26624
  buffer_load_dwordx4 a[88:91], v1, s[8:11], s29 offen offset:2048 sc1
  s_waitcnt vmcnt(19)
  v_mfma_f32_32x32x16_bf16 v[16:31], v[100:103], a[44:47], v[16:31]
  ds_read_b128 v[92:95], v1 offset:27648
  s_waitcnt lgkmcnt(4)
  v_mfma_f32_32x32x16_bf16 v[48:63], v[104:107], a[44:47], v[48:63]
  ds_read_b128 v[96:99], v2 offset:24576
  buffer_load_dwordx4 a[92:95], v1, s[8:11], s29 offen offset:3072 sc1
  v_mfma_f32_32x32x16_bf16 v[32:47], v[108:111], a[28:31], v[32:47]
  ds_read_b128 v[100:103], v1 offset:28672
  s_waitcnt vmcnt(19)
  s_waitcnt lgkmcnt(4)
  v_mfma_f32_32x32x16_bf16 v[16:31], v[80:83], a[48:51], v[16:31]
  ds_read_b128 v[104:107], v1 offset:29696
  s_add_u32 s29, s38, 13381632
  buffer_load_dwordx4 a[96:99], v1, s[8:11], s29 offen offset:0 sc1
  v_mfma_f32_32x32x16_bf16 v[48:63], v[84:87], a[48:51], v[48:63]
  ds_read_b128 v[108:111], v2 offset:25600
  s_waitcnt vmcnt(19)
  s_waitcnt lgkmcnt(4)
  v_mfma_f32_32x32x16_bf16 v[16:31], v[88:91], a[52:55], v[16:31]
  ds_read_b128 v[80:83], v1 offset:30720
  buffer_load_dwordx4 a[100:103], v1, s[8:11], s29 offen offset:1024 sc1
  v_mfma_f32_32x32x16_bf16 v[48:63], v[92:95], a[52:55], v[48:63]
  ds_read_b128 v[84:87], v1 offset:31744
  s_waitcnt lgkmcnt(4)
  v_mfma_f32_32x32x16_bf16 v[32:47], v[96:99], a[32:35], v[32:47]
  ds_read_b128 v[88:91], v1 offset:32768
  buffer_load_dwordx4 a[104:107], v1, s[8:11], s29 offen offset:2048 sc1
  s_waitcnt vmcnt(20)
  v_mfma_f32_32x32x16_bf16 v[16:31], v[100:103], a[56:59], v[16:31]
  ds_read_b128 v[92:95], v1 offset:33792
  s_waitcnt lgkmcnt(4)
  v_mfma_f32_32x32x16_bf16 v[48:63], v[104:107], a[56:59], v[48:63]
  ds_read_b128 v[96:99], v2 offset:26624
  buffer_load_dwordx4 a[108:111], v1, s[8:11], s29 offen offset:3072 sc1
  v_mfma_f32_32x32x16_bf16 v[32:47], v[108:111], a[36:39], v[32:47]
  ds_read_b128 v[100:103], v1 offset:34816
  s_waitcnt vmcnt(20)
  s_waitcnt lgkmcnt(4)
  v_mfma_f32_32x32x16_bf16 v[16:31], v[80:83], a[60:63], v[16:31]
  ds_read_b128 v[104:107], v1 offset:35840
  s_add_u32 s29, s38, 13385728
  buffer_load_dwordx4 a[112:115], v1, s[8:11], s29 offen offset:0 sc1
  v_mfma_f32_32x32x16_bf16 v[48:63], v[84:87], a[60:63], v[48:63]
  ds_read_b128 v[108:111], v2 offset:27648
  s_waitcnt vmcnt(12)
  s_waitcnt lgkmcnt(4)
  v_mfma_f32_32x32x16_bf16 v[16:31], v[88:91], a[64:67], v[16:31]
  ds_read_b128 v[80:83], v1 offset:36864
  buffer_load_dwordx4 a[116:119], v1, s[8:11], s29 offen offset:1024 sc1
  v_mfma_f32_32x32x16_bf16 v[48:63], v[92:95], a[64:67], v[48:63]
  ds_read_b128 v[84:87], v1 offset:37888
  s_waitcnt lgkmcnt(4)
  v_mfma_f32_32x32x16_bf16 v[32:47], v[96:99], a[40:43], v[32:47]
  ds_read_b128 v[88:91], v1 offset:38912
  buffer_load_dwordx4 a[120:123], v1, s[8:11], s29 offen offset:2048 sc1
  s_waitcnt vmcnt(13)
  v_mfma_f32_32x32x16_bf16 v[16:31], v[100:103], a[68:71], v[16:31]
  ds_read_b128 v[92:95], v1 offset:39936
  s_waitcnt lgkmcnt(4)
  v_mfma_f32_32x32x16_bf16 v[48:63], v[104:107], a[68:71], v[48:63]
  ds_read_b128 v[96:99], v2 offset:28672
  buffer_load_dwordx4 a[124:127], v1, s[8:11], s29 offen offset:3072 sc1
  v_mfma_f32_32x32x16_bf16 v[32:47], v[108:111], a[44:47], v[32:47]
  ds_read_b128 v[100:103], v1 offset:40960
  s_waitcnt vmcnt(13)
  s_waitcnt lgkmcnt(4)
  v_mfma_f32_32x32x16_bf16 v[16:31], v[80:83], a[72:75], v[16:31]
  ds_read_b128 v[104:107], v1 offset:41984
  s_add_u32 s29, s38, 13389824
  buffer_load_dwordx4 a[128:131], v1, s[8:11], s29 offen offset:0 sc1
  v_mfma_f32_32x32x16_bf16 v[48:63], v[84:87], a[72:75], v[48:63]
  ds_read_b128 v[108:111], v2 offset:29696
  s_waitcnt vmcnt(13)
  s_waitcnt lgkmcnt(4)
  v_mfma_f32_32x32x16_bf16 v[16:31], v[88:91], a[76:79], v[16:31]
  ds_read_b128 v[80:83], v1 offset:43008
  buffer_load_dwordx4 a[132:135], v1, s[8:11], s29 offen offset:1024 sc1
  v_mfma_f32_32x32x16_bf16 v[48:63], v[92:95], a[76:79], v[48:63]
  ds_read_b128 v[84:87], v1 offset:44032
  s_waitcnt lgkmcnt(4)
  v_mfma_f32_32x32x16_bf16 v[32:47], v[96:99], a[48:51], v[32:47]
  ds_read_b128 v[88:91], v1 offset:45056
  buffer_load_dwordx4 a[136:139], v1, s[8:11], s29 offen offset:2048 sc1
  s_waitcnt vmcnt(14)
  v_mfma_f32_32x32x16_bf16 v[16:31], v[100:103], a[80:83], v[16:31]
  ds_read_b128 v[92:95], v1 offset:46080
  s_waitcnt lgkmcnt(4)
  v_mfma_f32_32x32x16_bf16 v[48:63], v[104:107], a[80:83], v[48:63]
  ds_read_b128 v[96:99], v2 offset:30720
  buffer_load_dwordx4 a[140:143], v1, s[8:11], s29 offen offset:3072 sc1
  v_mfma_f32_32x32x16_bf16 v[32:47], v[108:111], a[52:55], v[32:47]
  ds_read_b128 v[100:103], v1 offset:47104
  s_waitcnt vmcnt(14)
  s_waitcnt lgkmcnt(4)
  v_mfma_f32_32x32x16_bf16 v[16:31], v[80:83], a[84:87], v[16:31]
  ds_read_b128 v[104:107], v1 offset:48128
  s_add_u32 s29, s38, 13393920
  buffer_load_dwordx4 a[144:147], v1, s[8:11], s29 offen offset:0 sc1
  v_mfma_f32_32x32x16_bf16 v[48:63], v[84:87], a[84:87], v[48:63]
  ds_read_b128 v[108:111], v2 offset:31744
  v_add_f32 v224, v224, v226
  v_add_f32 v225, v225, v227
  s_waitcnt vmcnt(14)
  s_waitcnt lgkmcnt(4)
  v_mfma_f32_32x32x16_bf16 v[16:31], v[88:91], a[88:91], v[16:31]
  ds_read_b128 v[80:83], v1 offset:49152
  buffer_load_dwordx4 a[148:151], v1, s[8:11], s29 offen offset:1024 sc1
  v_mfma_f32_32x32x16_bf16 v[48:63], v[92:95], a[88:91], v[48:63]
  ds_read_b128 v[84:87], v1 offset:50176
  v_add_f32 v228, v228, v230
  v_add_f32 v229, v229, v231
  v_add_f32 v224, v224, v228
  s_waitcnt lgkmcnt(4)
  v_mfma_f32_32x32x16_bf16 v[32:47], v[96:99], a[56:59], v[32:47]
  ds_read_b128 v[88:91], v1 offset:51200
  buffer_load_dwordx4 a[152:155], v1, s[8:11], s29 offen offset:2048 sc1
  s_waitcnt vmcnt(15)
  v_mfma_f32_32x32x16_bf16 v[16:31], v[100:103], a[92:95], v[16:31]
  ds_read_b128 v[92:95], v1 offset:52224
  v_add_f32 v225, v225, v229
  v_mov_b32 v226, v224
  s_waitcnt lgkmcnt(4)
  v_mfma_f32_32x32x16_bf16 v[48:63], v[104:107], a[92:95], v[48:63]
  ds_read_b128 v[96:99], v2 offset:32768
  buffer_load_dwordx4 a[156:159], v1, s[8:11], s29 offen offset:3072 sc1
  v_mfma_f32_32x32x16_bf16 v[32:47], v[108:111], a[60:63], v[32:47]
  ds_read_b128 v[100:103], v1 offset:53248
  v_mov_b32 v227, v225
  v_permlane32_swap_b32 v224, v226
  s_nop 0
  v_permlane32_swap_b32 v225, v227
  s_waitcnt vmcnt(15)
  s_waitcnt lgkmcnt(4)
  v_mfma_f32_32x32x16_bf16 v[16:31], v[80:83], a[96:99], v[16:31]
  ds_read_b128 v[104:107], v1 offset:54272
  buffer_store_dwordx4 v[164:167], v200, s[8:11], 0 offen sc1
  v_mfma_f32_32x32x16_bf16 v[48:63], v[84:87], a[96:99], v[48:63]
  ds_read_b128 v[108:111], v2 offset:33792
  v_add_f32 v224, v224, v226
  v_add_f32 v225, v225, v227
  s_waitcnt vmcnt(15)
  s_waitcnt lgkmcnt(4)
  v_mfma_f32_32x32x16_bf16 v[16:31], v[88:91], a[100:103], v[16:31]
  ds_read_b128 v[80:83], v1 offset:55296
  buffer_store_dwordx4 v[168:171], v201, s[8:11], 0 offen sc1
  v_mfma_f32_32x32x16_bf16 v[48:63], v[92:95], a[100:103], v[48:63]
  ds_read_b128 v[84:87], v1 offset:56320
  v_mul_f32 v224, 0xbacccccd, v224
  v_mul_f32 v225, 0x3acccccd, v225
  v_fma_f32 v225, -v224, v224, v225
  s_waitcnt lgkmcnt(4)
  v_mfma_f32_32x32x16_bf16 v[32:47], v[96:99], a[64:67], v[32:47]
  ds_read_b128 v[88:91], v1 offset:57344
  buffer_store_dwordx4 v[172:175], v202, s[8:11], 0 offen sc1
  s_waitcnt vmcnt(16)
  v_mfma_f32_32x32x16_bf16 v[16:31], v[100:103], a[104:107], v[16:31]
  ds_read_b128 v[92:95], v1 offset:58368
  v_cvt_pk_bf16_f32 v230, v224, v224
  v_max_f32 v225, 0, v225
  s_waitcnt lgkmcnt(4)
  v_mfma_f32_32x32x16_bf16 v[48:63], v[104:107], a[104:107], v[48:63]
  ds_read_b128 v[96:99], v2 offset:34816
  buffer_store_dwordx4 v[176:179], v203, s[8:11], 0 offen sc1
  v_mfma_f32_32x32x16_bf16 v[32:47], v[108:111], a[68:71], v[32:47]
  ds_read_b128 v[100:103], v1 offset:59392
  v_and_b32 v226, 0xffff0000, v230
  v_add_f32 v225, 0x3727c5ac, v225
  v_sub_f32 v226, v224, v226
  s_waitcnt vmcnt(16)
  s_waitcnt lgkmcnt(4)
  v_mfma_f32_32x32x16_bf16 v[16:31], v[80:83], a[108:111], v[16:31]
  ds_read_b128 v[104:107], v1 offset:60416
  buffer_store_dwordx4 v[180:183], v204, s[8:11], 0 offen sc1
  v_mfma_f32_32x32x16_bf16 v[48:63], v[84:87], a[108:111], v[48:63]
  ds_read_b128 v[108:111], v2 offset:35840
  v_rsq_f32 v232, v225
  s_waitcnt vmcnt(16)
  s_waitcnt lgkmcnt(4)
  v_mfma_f32_32x32x16_bf16 v[16:31], v[88:91], a[112:115], v[16:31]
  ds_read_b128 v[80:83], v1 offset:61440
  buffer_store_dwordx4 v[184:187], v205, s[8:11], 0 offen sc1
  v_mfma_f32_32x32x16_bf16 v[48:63], v[92:95], a[112:115], v[48:63]
  ds_read_b128 v[84:87], v1 offset:62464
  v_cvt_pk_bf16_f32 v231, v226, v4
  v_mul_f32 v233, 0x3ea52b5c, v232
  s_waitcnt lgkmcnt(4)
  v_mfma_f32_32x32x16_bf16 v[32:47], v[96:99], a[72:75], v[32:47]
  ds_read_b128 v[88:91], v1 offset:63488
  buffer_store_dwordx4 v[188:191], v206, s[8:11], 0 offen sc1
  s_waitcnt vmcnt(17)
  v_mfma_f32_32x32x16_bf16 v[16:31], v[100:103], a[116:119], v[16:31]
  ds_read_b128 v[92:95], v1 offset:64512
  s_waitcnt lgkmcnt(4)
  v_mfma_f32_32x32x16_bf16 v[48:63], v[104:107], a[116:119], v[48:63]
  ds_read_b128 v[96:99], v2 offset:36864
  buffer_store_dwordx4 v[192:195], v207, s[8:11], 0 offen sc1
  v_mfma_f32_32x32x16_bf16 v[32:47], v[108:111], a[76:79], v[32:47]
  ds_read_b128 v[100:103], v2 offset:0
  s_waitcnt vmcnt(17)
  s_waitcnt lgkmcnt(4)
  v_mfma_f32_32x32x16_bf16 v[16:31], v[80:83], a[120:123], v[16:31]
  ds_read_b128 v[104:107], v2 offset:1024
  buffer_store_dwordx4 v[196:199], v208, s[8:11], 0 offen sc1
  v_mfma_f32_32x32x16_bf16 v[48:63], v[84:87], a[120:123], v[48:63]
  ds_read_b128 v[108:111], v2 offset:37888
  s_waitcnt vmcnt(17)
  s_waitcnt lgkmcnt(4)
  v_mfma_f32_32x32x16_bf16 v[16:31], v[88:91], a[124:127], v[16:31]
  ds_read_b128 v[80:83], v2 offset:2048
  s_add_u32 s28, s54, 1957888
  s_add_u32 m0, s55, 122880
  s_nop 0
  buffer_load_dwordx4 v1, s[8:11], s28 offen offset:0 sc1 lds
  v_mfma_f32_32x32x16_bf16 v[48:63], v[92:95], a[124:127], v[48:63]
  ds_read_b128 v[84:87], v2 offset:3072
  s_waitcnt lgkmcnt(4)
  v_mfma_f32_32x32x16_bf16 v[32:47], v[96:99], a[80:83], v[32:47]
  ds_read_b128 v[88:91], v2 offset:4096
  buffer_load_dwordx4 v1, s[8:11], s28 offen offset:1024 sc1 lds
  s_waitcnt vmcnt(18)
  v_mfma_f32_32x32x16_bf16 v[16:31], v[100:103], a[128:131], v[16:31]
  ds_read_b128 v[92:95], v2 offset:5120
  s_waitcnt lgkmcnt(4)
  v_mfma_f32_32x32x16_bf16 v[48:63], v[104:107], a[128:131], v[48:63]
  ds_read_b128 v[96:99], v2 offset:38912
  buffer_load_dwordx4 v1, s[8:11], s28 offen offset:2048 sc1 lds
  v_mfma_f32_32x32x16_bf16 v[32:47], v[108:111], a[84:87], v[32:47]
  ds_read_b128 v[100:103], v2 offset:6144
  s_waitcnt vmcnt(18)
  s_waitcnt lgkmcnt(4)
  v_mfma_f32_32x32x16_bf16 v[16:31], v[80:83], a[132:135], v[16:31]
  ds_read_b128 v[104:107], v2 offset:7168
  buffer_load_dwordx4 v1, s[8:11], s28 offen offset:3072 sc1 lds
  v_mfma_f32_32x32x16_bf16 v[48:63], v[84:87], a[132:135], v[48:63]
  ds_read_b128 v[108:111], v2 offset:39936
  s_waitcnt vmcnt(18)
  s_waitcnt lgkmcnt(4)
  v_mfma_f32_32x32x16_bf16 v[16:31], v[88:91], a[136:139], v[16:31]
  ds_read_b128 v[80:83], v2 offset:8192
  s_add_u32 s28, s54, 1961984
  s_add_u32 m0, s55, 126976
  s_nop 0
  buffer_load_dwordx4 v1, s[8:11], s28 offen offset:0 sc1 lds
  v_mfma_f32_32x32x16_bf16 v[48:63], v[92:95], a[136:139], v[48:63]
  ds_read_b128 v[84:87], v2 offset:9216
  s_waitcnt lgkmcnt(4)
  v_mfma_f32_32x32x16_bf16 v[32:47], v[96:99], a[88:91], v[32:47]
  ds_read_b128 v[88:91], v2 offset:10240
  buffer_load_dwordx4 v1, s[8:11], s28 offen offset:1024 sc1 lds
  s_waitcnt vmcnt(19)
  v_mfma_f32_32x32x16_bf16 v[16:31], v[100:103], a[140:143], v[16:31]
  ds_read_b128 v[92:95], v2 offset:11264
  s_waitcnt lgkmcnt(4)
  v_mfma_f32_32x32x16_bf16 v[48:63], v[104:107], a[140:143], v[48:63]
  ds_read_b128 v[96:99], v2 offset:40960
  buffer_load_dwordx4 v1, s[8:11], s28 offen offset:2048 sc1 lds
  v_mfma_f32_32x32x16_bf16 v[32:47], v[108:111], a[92:95], v[32:47]
  ds_read_b128 v[100:103], v2 offset:12288
  s_waitcnt vmcnt(19)
  s_waitcnt lgkmcnt(4)
  v_mfma_f32_32x32x16_bf16 v[16:31], v[80:83], a[144:147], v[16:31]
  ds_read_b128 v[104:107], v2 offset:13312
  buffer_load_dwordx4 v1, s[8:11], s28 offen offset:3072 sc1 lds
  v_mfma_f32_32x32x16_bf16 v[48:63], v[84:87], a[144:147], v[48:63]
  ds_read_b128 v[108:111], v2 offset:41984
  s_waitcnt vmcnt(19)
  s_waitcnt lgkmcnt(4)
  v_mfma_f32_32x32x16_bf16 v[16:31], v[88:91], a[148:151], v[16:31]
  ds_read_b128 v[80:83], v2 offset:14336
  s_add_u32 s28, s54, 1966080
  s_add_u32 m0, s55, 131072
  s_nop 0
  buffer_load_dwordx4 v1, s[8:11], s28 offen offset:0 sc1 lds
  v_mfma_f32_32x32x16_bf16 v[48:63], v[92:95], a[148:151], v[48:63]
  ds_read_b128 v[84:87], v2 offset:15360
  s_waitcnt lgkmcnt(4)
  v_mfma_f32_32x32x16_bf16 v[32:47], v[96:99], a[96:99], v[32:47]
  ds_read_b128 v[88:91], v2 offset:43008
  buffer_load_dwordx4 v1, s[8:11], s28 offen offset:1024 sc1 lds
  s_waitcnt vmcnt(20)
  v_mfma_f32_32x32x16_bf16 v[16:31], v[100:103], a[152:155], v[16:31]
  ds_read_b128 v[92:95], v2 offset:44032
  s_waitcnt lgkmcnt(4)
  v_mfma_f32_32x32x16_bf16 v[48:63], v[104:107], a[152:155], v[48:63]
  ds_read_b128 v[96:99], v2 offset:45056
  v_mfma_f32_32x32x16_bf16 v[32:47], v[108:111], a[100:103], v[32:47]
  ds_read_b128 v[100:103], v2 offset:46080
  s_waitcnt vmcnt(19)
  s_waitcnt lgkmcnt(4)
  v_mfma_f32_32x32x16_bf16 v[16:31], v[80:83], a[156:159], v[16:31]
  ds_read_b128 v[104:107], v2 offset:47104
  v_mfma_f32_32x32x16_bf16 v[48:63], v[84:87], a[156:159], v[48:63]
  ds_read_b128 v[108:111], v2 offset:48128
  v_mfma_f32_32x32x8_bf16 v[16:31], v[156:157], v[230:231], v[16:31]
  v_mfma_f32_32x32x8_bf16 v[48:63], v[160:161], v[230:231], v[48:63]
  s_barrier
  s_waitcnt lgkmcnt(4)
  v_mfma_f32_32x32x16_bf16 v[32:47], v[88:91], a[104:107], v[32:47]
  ds_read_b128 v[80:83], v2 offset:49152
  v_mfma_f32_32x32x16_bf16 v[32:47], v[92:95], a[108:111], v[32:47]
  ds_read_b128 v[84:87], v2 offset:50176
  s_nop 4
  v_mul_f32 v16, v16, v232
  v_mul_f32 v17, v17, v232
  s_waitcnt lgkmcnt(4)
  v_mfma_f32_32x32x16_bf16 v[32:47], v[96:99], a[112:115], v[32:47]
  ds_read_b128 v[88:91], v2 offset:51200
  v_cvt_pk_bf16_f32 v112, v16, v17
  v_mul_f32 v18, v18, v232
  v_mul_f32 v19, v19, v232
  v_cvt_pk_bf16_f32 v113, v18, v19
  v_mfma_f32_32x32x16_bf16 v[32:47], v[100:103], a[116:119], v[32:47]
  ds_read_b128 v[92:95], v2 offset:52224
  v_mul_f32 v20, v20, v232
  v_mul_f32 v21, v21, v232
  v_cvt_pk_bf16_f32 v114, v20, v21
  v_mul_f32 v22, v22, v232
  s_waitcnt lgkmcnt(4)
  v_mfma_f32_32x32x16_bf16 v[32:47], v[104:107], a[120:123], v[32:47]
  ds_read_b128 v[96:99], v2 offset:53248
  v_mul_f32 v23, v23, v232
  v_cvt_pk_bf16_f32 v115, v22, v23
  buffer_store_dwordx4 v[112:115], v1, s[8:11], s46 offen sc1
  v_mfma_f32_32x32x16_bf16 v[32:47], v[108:111], a[124:127], v[32:47]
  ds_read_b128 v[100:103], v2 offset:54272
  v_mul_f32 v24, v24, v232
  v_mul_f32 v25, v25, v232
  v_cvt_pk_bf16_f32 v116, v24, v25
  v_mul_f32 v26, v26, v232
  s_waitcnt lgkmcnt(4)
  v_mfma_f32_32x32x16_bf16 v[32:47], v[80:83], a[128:131], v[32:47]
  ds_read_b128 v[104:107], v2 offset:55296
  v_mul_f32 v27, v27, v232
  v_cvt_pk_bf16_f32 v117, v26, v27
  v_mul_f32 v28, v28, v232
  v_mul_f32 v29, v29, v232
  v_mfma_f32_32x32x16_bf16 v[32:47], v[84:87], a[132:135], v[32:47]
  ds_read_b128 v[108:111], v2 offset:56320
  v_cvt_pk_bf16_f32 v118, v28, v29
  v_mul_f32 v30, v30, v232
  v_mul_f32 v31, v31, v232
  v_cvt_pk_bf16_f32 v119, v30, v31
  s_waitcnt lgkmcnt(4)
  v_mfma_f32_32x32x16_bf16 v[32:47], v[88:91], a[136:139], v[32:47]
  s_waitcnt vmcnt(1)
  s_barrier
  s_cmp_lg_u32 s18, 0
  s_cbranch_scc1 PF2
  s_lshl_b32 s30, s16, 13
  s_lshl_b32 s31, s17, 9
  s_add_u32 s30, s30, s31
  s_add_u32 s30, s30, 12075136
  v_mov_b32 v14, s25
  s_mov_b64 exec, 1
  buffer_store_dword v14, v4, s[8:11], s30 offen sc1
  s_mov_b64 exec, -1
PF2:
  ds_read_b128 v[80:83], v2 offset:57344
  buffer_store_dwordx4 v[116:119], v1, s[8:11], s46 offen offset:1024 sc1
  v_mul_f32 v48, v48, v232
  v_mul_f32 v49, v49, v232
  v_mfma_f32_32x32x16_bf16 v[32:47], v[92:95], a[140:143], v[32:47]
  ds_read_b128 v[84:87], v2 offset:58368
  v_cvt_pk_bf16_f32 v120, v48, v49
  v_mul_f32 v50, v50, v232
  v_mul_f32 v51, v51, v232
  v_cvt_pk_bf16_f32 v121, v50, v51
  s_waitcnt lgkmcnt(4)
  v_mfma_f32_32x32x16_bf16 v[32:47], v[96:99], a[144:147], v[32:47]
  ds_read_b128 v[88:91], v2 offset:59392
  buffer_store_dwordx2 v[120:121], v133, s[8:11], s46 offen offset:2048 sc1
  ds_write_b128 v132, v[112:115]
  ds_write_b128 v132, v[116:119] offset:1024
  v_mfma_f32_32x32x16_bf16 v[32:47], v[100:103], a[148:151], v[32:47]
  ds_read_b128 v[92:95], v2 offset:60416
  ds_write_b64 v134, v[120:121] offset:2048
  v_mul_f32 v56, v56, v233
  v_mul_f32 v57, v57, v233
  v_cvt_pk_bf16_f32 v216, v56, v57
  s_waitcnt lgkmcnt(7)
  v_mfma_f32_32x32x16_bf16 v[32:47], v[104:107], a[152:155], v[32:47]
  ds_read_b128 v[96:99], v2 offset:61440
  v_mul_f32 v58, v58, v233
  v_mul_f32 v59, v59, v233
  v_cvt_pk_bf16_f32 v217, v58, v59
  v_mul_f32 v60, v60, v233
  v_mfma_f32_32x32x16_bf16 v[32:47], v[108:111], a[156:159], v[32:47]
  ds_read_b128 v[100:103], v2 offset:62464
  v_mul_f32 v61, v61, v233
  v_cvt_pk_bf16_f32 v218, v60, v61
  v_mul_f32 v62, v62, v233
  v_mul_f32 v63, v63, v233
  v_mfma_f32_32x32x8_bf16 v[32:47], v[158:159], v[230:231], v[32:47]
  s_waitcnt lgkmcnt(7)
  v_mfma_f32_32x32x16_bf16 v[64:79], v[80:83], a[0:3], 0
  ds_read_b128 v[104:107], v2 offset:63488
  v_mul_f32 v52, v52, v232
  v_mul_f32 v53, v53, v232
  v_cvt_pk_bf16_f32 v122, v52, v53
  v_mul_f32 v54, v54, v232
  v_mfma_f32_32x32x16_bf16 v[64:79], v[84:87], a[4:7], v[64:79]
  ds_read_b128 v[108:111], v2 offset:64512
  v_mul_f32 v55, v55, v232
  v_cvt_pk_bf16_f32 v123, v54, v55
  ds_write_b64 v137, v[122:123] offset:32
  ds_write_b64 v137, v[138:139] offset:40
  s_waitcnt lgkmcnt(7)
  v_mfma_f32_32x32x16_bf16 v[64:79], v[88:91], a[8:11], v[64:79]
  ds_read_b128 v[80:83], v3 offset:0
  v_mul_f32 v32, v32, v232
  v_mul_f32 v33, v33, v232
  v_cvt_pk_bf16_f32 v124, v32, v33
  v_mul_f32 v34, v34, v232
  v_mfma_f32_32x32x16_bf16 v[64:79], v[92:95], a[12:15], v[64:79]
  ds_read_b128 v[84:87], v3 offset:1024
  v_mul_f32 v35, v35, v232
  v_cvt_pk_bf16_f32 v125, v34, v35
  v_mul_f32 v36, v36, v232
  v_mul_f32 v37, v37, v232
  s_waitcnt lgkmcnt(6)
  v_mfma_f32_32x32x16_bf16 v[64:79], v[96:99], a[16:19], v[64:79]
  ds_read_b128 v[88:91], v3 offset:2048
  v_cvt_pk_bf16_f32 v126, v36, v37
  v_mul_f32 v38, v38, v232
  v_mul_f32 v39, v39, v232
  v_cvt_pk_bf16_f32 v127, v38, v39
  v_mfma_f32_32x32x16_bf16 v[64:79], v[100:103], a[20:23], v[64:79]
  ds_read_b128 v[92:95], v3 offset:3072
  ds_write_b64 v136, v[124:125] offset:0
  ds_write_b64 v136, v[126:127] offset:16
  v_mul_f32 v40, v40, v232
  v_mul_f32 v41, v41, v232
  s_waitcnt lgkmcnt(8)
  v_mfma_f32_32x32x16_bf16 v[64:79], v[104:107], a[24:27], v[64:79]
  ds_read_b128 v[96:99], v3 offset:4096
  v_cvt_pk_bf16_f32 v128, v40, v41
  v_mul_f32 v42, v42, v232
  v_mul_f32 v43, v43, v232
  v_cvt_pk_bf16_f32 v129, v42, v43
  v_mfma_f32_32x32x16_bf16 v[64:79], v[108:111], a[28:31], v[64:79]
  ds_read_b128 v[100:103], v3 offset:5120
  v_mul_f32 v44, v44, v232
  v_mul_f32 v45, v45, v232
  v_cvt_pk_bf16_f32 v130, v44, v45
  v_mul_f32 v46, v46, v232
  s_waitcnt lgkmcnt(6)
  v_mfma_f32_32x32x16_bf16 v[64:79], v[80:83], a[32:35], v[64:79]
  ds_read_b128 v[104:107], v3 offset:6144
  v_mul_f32 v47, v47, v232
  v_cvt_pk_bf16_f32 v131, v46, v47
  ds_write_b64 v136, v[128:129] offset:1536
  ds_write_b64 v136, v[130:131] offset:1552
  v_mfma_f32_32x32x16_bf16 v[64:79], v[84:87], a[36:39], v[64:79]
  ds_read_b128 v[108:111], v3 offset:7168
  ds_read_b128 v[144:147], v135 offset:0
  ds_read_b128 v[148:151], v135 offset:1024
  ds_read_b128 v[152:155], v135 offset:2048
  s_waitcnt lgkmcnt(11)
  v_mfma_f32_32x32x16_bf16 v[64:79], v[88:91], a[40:43], v[64:79]
  ds_read_b128 v[80:83], v3 offset:8192
  v_mfma_f32_32x32x16_bf16 v[64:79], v[92:95], a[44:47], v[64:79]
  ds_read_b128 v[84:87], v3 offset:9216
  s_waitcnt lgkmcnt(9)
  v_mfma_f32_32x32x16_bf16 v[64:79], v[96:99], a[48:51], v[64:79]
  ds_read_b128 v[88:91], v3 offset:10240
  s_waitcnt lgkmcnt(5)
  buffer_store_dwordx4 v[144:147], v1, s[8:11], s47 offen offset:0 sc1
  v_mfma_f32_32x32x16_bf16 v[64:79], v[100:103], a[52:55], v[64:79]
  ds_read_b128 v[92:95], v3 offset:11264
  s_waitcnt lgkmcnt(5)
  buffer_store_dwordx4 v[148:151], v1, s[8:11], s47 offen offset:1024 sc1
  s_waitcnt lgkmcnt(4)
  buffer_store_dwordx4 v[152:155], v1, s[8:11], s47 offen offset:2048 sc1
  v_mfma_f32_32x32x16_bf16 v[64:79], v[104:107], a[56:59], v[64:79]
  ds_read_b128 v[96:99], v3 offset:12288
  v_cvt_pk_bf16_f32 v219, v62, v63
  v_mfma_f32_32x32x16_bf16 v[64:79], v[108:111], a[60:63], v[64:79]
  ds_read_b128 v[100:103], v3 offset:13312
  s_waitcnt lgkmcnt(4)
  v_mfma_f32_32x32x16_bf16 v[64:79], v[80:83], a[64:67], v[64:79]
  ds_read_b128 v[104:107], v3 offset:14336
  v_mfma_f32_32x32x16_bf16 v[64:79], v[84:87], a[68:71], v[64:79]
  ds_read_b128 v[108:111], v3 offset:15360
  s_waitcnt lgkmcnt(4)
  v_mfma_f32_32x32x16_bf16 v[64:79], v[88:91], a[72:75], v[64:79]
  ds_read_b128 v[80:83], v3 offset:16384
  v_mfma_f32_32x32x16_bf16 v[64:79], v[92:95], a[76:79], v[64:79]
  ds_read_b128 v[84:87], v3 offset:17408
  s_waitcnt lgkmcnt(4)
  v_mfma_f32_32x32x16_bf16 v[64:79], v[96:99], a[80:83], v[64:79]
  ds_read_b128 v[88:91], v3 offset:18432
  v_mfma_f32_32x32x16_bf16 v[64:79], v[100:103], a[84:87], v[64:79]
  ds_read_b128 v[92:95], v3 offset:19456
  s_waitcnt lgkmcnt(4)
  v_mfma_f32_32x32x16_bf16 v[64:79], v[104:107], a[88:91], v[64:79]
  ds_read_b128 v[96:99], v3 offset:20480
  v_mfma_f32_32x32x16_bf16 v[64:79], v[108:111], a[92:95], v[64:79]
  ds_read_b128 v[100:103], v3 offset:21504
  s_waitcnt lgkmcnt(4)
  v_mfma_f32_32x32x16_bf16 v[64:79], v[80:83], a[96:99], v[64:79]
  ds_read_b128 v[104:107], v3 offset:22528
  v_mfma_f32_32x32x16_bf16 v[64:79], v[84:87], a[100:103], v[64:79]
  ds_read_b128 v[108:111], v3 offset:23552
  s_and_b32 s24, s17, 11
  s_lshl_b32 s24, s24, 9
  s_add_u32 s24, s24, 12075136
  v_and_b32 v225, 15, v5
  v_lshlrev_b32 v225, 13, v225
  v_and_b32 v224, 16, v5
  v_lshl_add_u32 v225, v224, 7, v225
  v_mov_b32 v224, s25
  s_mov_b64 exec, 0xffffffff
  buffer_load_dword v224, v225, s[8:11], s24 offen sc1
  s_mov_b64 exec, -1
  s_waitcnt lgkmcnt(4)
  v_mfma_f32_32x32x16_bf16 v[64:79], v[88:91], a[104:107], v[64:79]
  ds_read_b128 v[80:83], v3 offset:24576
  v_mfma_f32_32x32x16_bf16 v[64:79], v[92:95], a[108:111], v[64:79]
  ds_read_b128 v[84:87], v3 offset:25600
  s_waitcnt lgkmcnt(4)
  v_mfma_f32_32x32x16_bf16 v[64:79], v[96:99], a[112:115], v[64:79]
  ds_read_b128 v[88:91], v3 offset:26624
  v_mfma_f32_32x32x16_bf16 v[64:79], v[100:103], a[116:119], v[64:79]
  ds_read_b128 v[92:95], v3 offset:27648
  s_waitcnt lgkmcnt(4)
  v_mfma_f32_32x32x16_bf16 v[64:79], v[104:107], a[120:123], v[64:79]
  ds_read_b128 v[96:99], v3 offset:28672
  s_mul_i32 s30, s19, 917504
  s_lshl_b32 s31, s16, 13
  s_add_u32 s30, s30, s31
  s_add_u32 s30, s30, 524288
  s_add_u32 s30, s30, s22
  v_mov_b32 v14, s25
  s_waitcnt vmcnt(4)
  s_mov_b64 exec, 1
  buffer_store_dword v14, v4, s[8:11], s30 offen sc1
  s_mov_b64 exec, -1
  v_mfma_f32_32x32x16_bf16 v[64:79], v[108:111], a[124:127], v[64:79]
  ds_read_b128 v[100:103], v3 offset:29696
  s_waitcnt lgkmcnt(4)
  v_mfma_f32_32x32x16_bf16 v[64:79], v[80:83], a[128:131], v[64:79]
  ds_read_b128 v[104:107], v3 offset:30720
  v_mfma_f32_32x32x16_bf16 v[64:79], v[84:87], a[132:135], v[64:79]
  ds_read_b128 v[108:111], v3 offset:31744
  s_waitcnt lgkmcnt(4)
  v_mfma_f32_32x32x16_bf16 v[64:79], v[88:91], a[136:139], v[64:79]
  v_mfma_f32_32x32x16_bf16 v[64:79], v[92:95], a[140:143], v[64:79]
  s_waitcnt lgkmcnt(2)
  v_mfma_f32_32x32x16_bf16 v[64:79], v[96:99], a[144:147], v[64:79]
  v_mfma_f32_32x32x16_bf16 v[64:79], v[100:103], a[148:151], v[64:79]
  s_waitcnt lgkmcnt(0)
  v_mfma_f32_32x32x16_bf16 v[64:79], v[104:107], a[152:155], v[64:79]
  v_mfma_f32_32x32x16_bf16 v[64:79], v[108:111], a[156:159], v[64:79]
  v_mfma_f32_32x32x8_bf16 v[64:79], v[162:163], v[230:231], v[64:79]
  s_nop 4
  s_nop 6
  v_mul_f32 v64, v64, v233
  v_mul_f32 v65, v65, v233
  v_cvt_pk_bf16_f32 v220, v64, v65
  v_mul_f32 v66, v66, v233
  v_mul_f32 v67, v67, v233
  v_cvt_pk_bf16_f32 v221, v66, v67
  v_mul_f32 v68, v68, v233
  v_mul_f32 v69, v69, v233
  v_cvt_pk_bf16_f32 v222, v68, v69
  v_mul_f32 v70, v70, v233
  v_mul_f32 v71, v71, v233
  v_cvt_pk_bf16_f32 v223, v70, v71
  v_mul_f32 v72, v72, v233
  v_mul_f32 v73, v73, v233
  v_cvt_pk_bf16_f32 v230, v72, v73
  v_mul_f32 v74, v74, v233
  v_mul_f32 v75, v75, v233
  v_cvt_pk_bf16_f32 v231, v74, v75
  v_cmp_gt_u32 vcc, 32, v5
  s_nop 1
  v_cndmask_b32 v228, 0, v230, vcc
  v_cndmask_b32 v229, 0, v231, vcc
  v_cndmask_b32 v230, v230, v4, vcc
  v_cndmask_b32 v231, v231, v4, vcc
  s_mul_i32 s33, s18, 2560
  v_add_u32 v130, s33, v1
  v_add_u32 v131, s33, v133
  s_mul_i32 s33, s18, 3072
  s_add_u32 s33, s33, 30720
  v_bfe_u32 v132, v5, 2, 2
  v_lshrrev_b32 v133, 4, v6
  v_add_u32 v132, v132, v133
  v_mul_u32_u24 v132, 48, v132
  v_and_b32 v133, 3, v5
  v_lshlrev_b32 v134, 3, v133
  v_min_u32 v133, 1, v133
  v_lshlrev_b32 v133, 3, v133
  v_add_u32 v133, 32, v133
  v_and_b32 v135, 16, v5
  v_cmp_eq_u32 vcc, 0, v135
  s_nop 1
  v_cndmask_b32 v133, v133, v134, vcc
  v_add3_u32 v132, v132, v133, s33
  v_mov_b32 v135, 0xf149f2ca
  v_mov_b32 v133, v135
  v_mov_b32 v134, v135
  s_mov_b32 s26, 0
  s_mul_i32 s49, s19, 2621440
  s_lshl_b32 s35, s16, 3
  s_lshl_b32 s33, s18, 1
  s_add_u32 s35, s35, s33
  s_mul_i32 s35, s35, 20480
  s_add_u32 s49, s49, s35
  s_mul_i32 s35, s17, 1280
  s_add_u32 s49, s49, s35
  s_add_u32 s49, s49, 35901440
  s_cmp_lg_u32 s19, 0
  s_cbranch_scc1 L_c1
  s_waitcnt vmcnt(1)
  v_cmp_ne_u32 vcc, s25, v224
  s_cbranch_vccz PL_2_k
  s_mov_b32 s32, 0x40000
  s_mov_b64 exec, 0xffffffff
PL_2_p:
  buffer_load_dword v224, v225, s[8:11], s24 offen sc1
  s_sub_u32 s32, s32, 1
  s_cbranch_scc1 PL_2_d
  s_waitcnt vmcnt(0)
  v_cmp_ne_u32 vcc, s25, v224
  s_cbranch_vccnz PL_2_p
PL_2_d:
  s_mov_b64 exec, -1
PL_2_k:
  s_mul_i32 s30, s17, 22528
  s_lshl_b32 s31, s18, 7
  s_add_u32 s30, s30, s31
  s_add_u32 s30, s30, 12206592
  v_mul_u32_u24 v14, 176, v6
  v_and_b32 v15, 31, v5
  v_lshl_add_u32 v14, v15, 2, v14
  buffer_load_dword v144, v14, s[8:11], s30 offen offset:0 sc1
  buffer_load_dword v145, v14, s[8:11], s30 offen offset:1408 sc1
  s_add_u32 s30, s30, 2816
  buffer_load_dword v146, v14, s[8:11], s30 offen offset:0 sc1
  buffer_load_dword v147, v14, s[8:11], s30 offen offset:1408 sc1
  s_add_u32 s30, s30, 2816
  buffer_load_dword v148, v14, s[8:11], s30 offen offset:0 sc1
  buffer_load_dword v149, v14, s[8:11], s30 offen offset:1408 sc1
  s_add_u32 s30, s30, 2816
  buffer_load_dword v150, v14, s[8:11], s30 offen offset:0 sc1
  buffer_load_dword v151, v14, s[8:11], s30 offen offset:1408 sc1
  s_mul_i32 s30, s17, 22528
  s_lshl_b32 s31, s18, 7
  s_add_u32 s30, s30, s31
  s_add_u32 s30, s30, 12207104
  v_mul_u32_u24 v14, 176, v6
  v_and_b32 v15, 31, v5
  v_lshl_add_u32 v14, v15, 2, v14
  buffer_load_dword v152, v14, s[8:11], s30 offen offset:0 sc1
  buffer_load_dword v153, v14, s[8:11], s30 offen offset:1408 sc1
  s_add_u32 s30, s30, 2816
  buffer_load_dword v154, v14, s[8:11], s30 offen offset:0 sc1
  buffer_load_dword v155, v14, s[8:11], s30 offen offset:1408 sc1
  s_add_u32 s30, s30, 2816
  buffer_load_dword v156, v14, s[8:11], s30 offen offset:0 sc1
  buffer_load_dword v157, v14, s[8:11], s30 offen offset:1408 sc1
  s_add_u32 s30, s30, 2816
  buffer_load_dword v158, v14, s[8:11], s30 offen offset:0 sc1
  buffer_load_dword v159, v14, s[8:11], s30 offen offset:1408 sc1
L_c1:
  s_lshr_b32 s33, s18, 1
  s_add_u32 s23, s33, s16
  s_lshl_b32 s33, s23, 13
  s_mul_i32 s24, s19, 917504
  s_add_u32 s24, s24, s33
  s_lshl_b32 s33, s17, 9
  s_add_u32 s24, s24, s33
  s_and_b32 s33, s18, 1
  s_lshl_b32 s33, s33, 8
  s_add_u32 s24, s24, s33
  s_add_u32 s24, s24, 507904
  v_lshlrev_b32 v225, 7, v5
  v_mov_b32 v224, s25
  s_mov_b64 exec, 3
  buffer_load_dword v224, v225, s[8:11], s24 offen sc1
  s_mov_b64 exec, -1
L_att:
  ds_read_b128 a[32:35], v130 offset:20480
  ds_read_b64 a[88:89], v131 offset:22528
  ds_read_b128 a[68:71], v130 offset:21504
  ds_read_b64_tr_b16 a[92:93], v132 offset:24576
  ds_read_b64_tr_b16 a[94:95], v132 offset:24960
  ds_read_b64_tr_b16 a[96:97], v132 offset:25344
  ds_read_b64_tr_b16 a[98:99], v132 offset:25728
  ds_read_b64_tr_b16 a[124:125], v132 offset:26112
  ds_read_b64_tr_b16 a[126:127], v132 offset:26496
  ds_read_b64_tr_b16 a[128:129], v132 offset:26880
  ds_read_b64_tr_b16 a[130:131], v132 offset:27264
  v_cndmask_b32 v48, v135, v4, s[56:57]
  v_cndmask_b32 v49, v135, v4, s[58:59]
  v_cndmask_b32 v50, v135, v4, s[60:61]
  v_cndmask_b32 v51, v135, v4, s[62:63]
  v_cndmask_b32 v52, v135, v4, s[64:65]
  v_cndmask_b32 v53, v135, v4, s[66:67]
  v_cndmask_b32 v54, v135, v4, s[68:69]
  v_cndmask_b32 v55, v135, v4, s[70:71]
  v_cndmask_b32 v56, v135, v4, s[72:73]
  v_cndmask_b32 v57, v135, v4, s[74:75]
  v_cndmask_b32 v58, v135, v4, s[76:77]
  v_cndmask_b32 v59, v135, v4, s[78:79]
  v_cndmask_b32 v60, v135, v4, s[80:81]
  v_cndmask_b32 v61, v135, v4, s[82:83]
  v_cndmask_b32 v62, v135, v4, s[84:85]
  v_cndmask_b32 v63, v135, v4, s[86:87]
  s_waitcnt lgkmcnt(8)
  s_nop 0
  v_mfma_f32_32x32x16_bf16 v[16:31], a[32:35], v[216:219], v[48:63]
  v_mfma_f32_32x32x16_bf16 v[32:47], a[68:71], v[220:223], v[48:63]
  v_mfma_f32_32x32x8_bf16 v[16:31], a[88:89], v[228:229], v[16:31]
  v_mfma_f32_32x32x8_bf16 v[32:47], a[88:89], v[230:231], v[32:47]
  s_nop 10
  v_max3_f32 v128, v16, v17, v133
  v_max3_f32 v128, v18, v19, v128
  v_max3_f32 v128, v20, v21, v128
  v_max3_f32 v128, v22, v23, v128
  v_max3_f32 v128, v24, v25, v128
  v_max3_f32 v128, v26, v27, v128
  v_max3_f32 v128, v28, v29, v128
  v_max3_f32 v128, v30, v31, v128
  v_mov_b32 v136, v128
  s_nop 1
  v_permlane32_swap_b32 v128, v136
  v_max_f32 v128, v128, v136
  v_sub_f32 v128, 0, v128
  v_max3_f32 v129, v32, v33, v134
  v_max3_f32 v129, v34, v35, v129
  v_max3_f32 v129, v36, v37, v129
  v_max3_f32 v129, v38, v39, v129
  v_max3_f32 v129, v40, v41, v129
  v_max3_f32 v129, v42, v43, v129
  v_max3_f32 v129, v44, v45, v129
  v_max3_f32 v129, v46, v47, v129
  v_mov_b32 v136, v129
  s_nop 1
  v_permlane32_swap_b32 v129, v136
  v_max_f32 v129, v129, v136
  v_sub_f32 v129, 0, v129
  v_pk_add_f32 v[16:17], v[16:17], v[128:129] op_sel_hi:[1,0]
  v_pk_add_f32 v[18:19], v[18:19], v[128:129] op_sel_hi:[1,0]
  v_pk_add_f32 v[20:21], v[20:21], v[128:129] op_sel_hi:[1,0]
  v_pk_add_f32 v[22:23], v[22:23], v[128:129] op_sel_hi:[1,0]
  v_pk_add_f32 v[24:25], v[24:25], v[128:129] op_sel_hi:[1,0]
  v_pk_add_f32 v[26:27], v[26:27], v[128:129] op_sel_hi:[1,0]
  v_pk_add_f32 v[28:29], v[28:29], v[128:129] op_sel_hi:[1,0]
  v_pk_add_f32 v[30:31], v[30:31], v[128:129] op_sel_hi:[1,0]
  v_pk_add_f32 v[32:33], v[32:33], v[128:129] op_sel:[0,1] op_sel_hi:[1,1]
  v_pk_add_f32 v[34:35], v[34:35], v[128:129] op_sel:[0,1] op_sel_hi:[1,1]
  v_pk_add_f32 v[36:37], v[36:37], v[128:129] op_sel:[0,1] op_sel_hi:[1,1]
  v_pk_add_f32 v[38:39], v[38:39], v[128:129] op_sel:[0,1] op_sel_hi:[1,1]
  v_pk_add_f32 v[40:41], v[40:41], v[128:129] op_sel:[0,1] op_sel_hi:[1,1]
  v_pk_add_f32 v[42:43], v[42:43], v[128:129] op_sel:[0,1] op_sel_hi:[1,1]
  v_pk_add_f32 v[44:45], v[44:45], v[128:129] op_sel:[0,1] op_sel_hi:[1,1]
  v_pk_add_f32 v[46:47], v[46:47], v[128:129] op_sel:[0,1] op_sel_hi:[1,1]
  v_pk_add_f32 v[96:97], v[128:129], 0 op_sel_hi:[0,0]
  v_pk_add_f32 v[98:99], v[128:129], 0 op_sel_hi:[0,0]
  v_pk_add_f32 v[100:101], v[128:129], 0 op_sel_hi:[0,0]
  v_pk_add_f32 v[102:103], v[128:129], 0 op_sel_hi:[0,0]
  v_pk_add_f32 v[104:105], v[128:129], 0 op_sel_hi:[0,0]
  v_pk_add_f32 v[106:107], v[128:129], 0 op_sel_hi:[0,0]
  v_pk_add_f32 v[108:109], v[128:129], 0 op_sel_hi:[0,0]
  v_pk_add_f32 v[110:111], v[128:129], 0 op_sel_hi:[0,0]
  s_cmp_lg_u32 s26, 0
  s_cbranch_scc1 AT_3_nk
  s_mul_i32 s30, s19, 917504
  s_lshl_b32 s31, s16, 13
  s_add_u32 s30, s30, s31
  s_add_u32 s30, s30, 655360
  s_add_u32 s30, s30, s22
  v_mov_b32 v14, s25
  s_waitcnt vmcnt(3)
  s_mov_b64 exec, 1
  buffer_store_dword v14, v4, s[8:11], s30 offen sc1
  s_mov_b64 exec, -1
  s_cmp_lt_u32 s23, 2
  s_cbranch_scc1 AT_3_nk
  s_waitcnt vmcnt(1)
  v_cmp_ne_u32 vcc, s25, v224
  s_cbranch_vccz PL_4_k
  s_mov_b32 s32, 0x40000
  s_mov_b64 exec, 3
PL_4_p:
  buffer_load_dword v224, v225, s[8:11], s24 offen sc1
  s_sub_u32 s32, s32, 1
  s_cbranch_scc1 PL_4_d
  s_waitcnt vmcnt(0)
  v_cmp_ne_u32 vcc, s25, v224
  s_cbranch_vccnz PL_4_p
PL_4_d:
  s_mov_b64 exec, -1
PL_4_k:
  s_mul_i32 s34, s18, 5120
  s_add_u32 s33, s44, s34
  s_add_u32 s28, s33, -20480
  s_add_u32 m0, s34, 0
  s_nop 0
  buffer_load_dwordx4 v1, s[8:11], s28 offen offset:0 sc1 lds
  buffer_load_dwordx4 v1, s[8:11], s28 offen offset:1024 sc1 lds
  buffer_load_dwordx4 v1, s[8:11], s28 offen offset:2048 sc1 lds
  buffer_load_dwordx4 v1, s[8:11], s28 offen offset:3072 sc1 lds
  s_add_u32 s28, s33, -16384
  s_add_u32 m0, s34, 4096
  s_nop 0
  buffer_load_dwordx4 v1, s[8:11], s28 offen offset:0 sc1 lds
AT_3_nk:
  v_exp_f32 v16, v16
  v_exp_f32 v17, v17
  v_exp_f32 v18, v18
  v_exp_f32 v19, v19
  v_exp_f32 v20, v20
  v_exp_f32 v21, v21
  v_exp_f32 v22, v22
  v_exp_f32 v23, v23
  v_exp_f32 v24, v24
  v_exp_f32 v25, v25
  v_exp_f32 v26, v26
  v_exp_f32 v27, v27
  v_exp_f32 v28, v28
  v_exp_f32 v29, v29
  v_exp_f32 v30, v30
  v_exp_f32 v31, v31
  v_cvt_pk_bf16_f32 v112, v16, v17
  v_cvt_pk_bf16_f32 v113, v18, v19
  v_cvt_pk_bf16_f32 v114, v20, v21
  v_cvt_pk_bf16_f32 v115, v22, v23
  v_cvt_pk_bf16_f32 v116, v24, v25
  v_cvt_pk_bf16_f32 v117, v26, v27
  v_cvt_pk_bf16_f32 v118, v28, v29
  v_cvt_pk_bf16_f32 v119, v30, v31
  s_waitcnt lgkmcnt(4)
  v_mfma_f32_32x32x16_bf16 v[64:79], a[92:95], v[112:115], 0
  v_mfma_f32_32x32x16_bf16 v[64:79], a[96:99], v[116:119], v[64:79]
  v_exp_f32 v32, v32
  v_exp_f32 v33, v33
  v_exp_f32 v34, v34
  v_exp_f32 v35, v35
  v_exp_f32 v36, v36
  v_exp_f32 v37, v37
  v_exp_f32 v38, v38
  v_exp_f32 v39, v39
  v_exp_f32 v40, v40
  v_exp_f32 v41, v41
  v_exp_f32 v42, v42
  v_exp_f32 v43, v43
  v_exp_f32 v44, v44
  v_exp_f32 v45, v45
  v_exp_f32 v46, v46
  v_exp_f32 v47, v47
  v_cvt_pk_bf16_f32 v120, v32, v33
  v_cvt_pk_bf16_f32 v121, v34, v35
  v_cvt_pk_bf16_f32 v122, v36, v37
  v_cvt_pk_bf16_f32 v123, v38, v39
  v_cvt_pk_bf16_f32 v124, v40, v41
  v_cvt_pk_bf16_f32 v125, v42, v43
  v_cvt_pk_bf16_f32 v126, v44, v45
  v_cvt_pk_bf16_f32 v127, v46, v47
  s_waitcnt lgkmcnt(0)
  v_mfma_f32_32x32x16_bf16 v[80:95], a[124:127], v[120:123], 0
  v_mfma_f32_32x32x16_bf16 v[80:95], a[128:131], v[124:127], v[80:95]
  s_cmp_lg_u32 s26, 0
  s_cbranch_scc1 AT_3_nf
  s_waitcnt vmcnt(0)
  s_waitcnt lgkmcnt(0)
  s_barrier
  s_cmp_lg_u32 s19, 0
  s_cbranch_scc1 L_c2
  v_pk_add_f32 v[144:145], v[144:145], v[146:147]
  v_pk_add_f32 v[148:149], v[148:149], v[150:151]
  v_pk_add_f32 v[144:145], v[144:145], v[148:149]
  v_add_f32 v144, v144, v145
  v_mov_b32 v145, v144
  s_nop 1
  v_permlane32_swap_b32 v144, v145
  v_add_f32 v144, v144, v145
  v_cvt_pk_bf16_f32 v147, v144, v144
  v_and_b32 v145, 0xffff0000, v147
  v_sub_f32 v145, v144, v145
  v_cvt_pk_bf16_f32 v146, v144, v145
  v_and_b32 v147, 0xffff, v147
  v_lshlrev_b32 v15, 24, v6
  v_lshl_add_u32 v15, v5, 3, v15
  s_lshl_b32 s31, s18, 8
  s_add_u32 s31, s31, s88
  buffer_store_dwordx2 v[146:147], v15, s[8:11], s31 offen offset:1024
  v_pk_add_f32 v[152:153], v[152:153], v[154:155]
  v_pk_add_f32 v[156:157], v[156:157], v[158:159]
  v_pk_add_f32 v[152:153], v[152:153], v[156:157]
  v_add_f32 v152, v152, v153
  v_mov_b32 v153, v152
  s_nop 1
  v_permlane32_swap_b32 v152, v153
  v_add_f32 v152, v152, v153
  v_cvt_pk_bf16_f32 v155, v152, v152
  v_and_b32 v153, 0xffff0000, v155
  v_sub_f32 v153, v152, v153
  v_cvt_pk_bf16_f32 v154, v152, v153
  v_and_b32 v155, 0xffff, v155
  v_lshlrev_b32 v15, 24, v6
  v_lshl_add_u32 v15, v5, 3, v15
  s_lshl_b32 s31, s18, 8
  s_add_u32 s31, s31, s88
  buffer_store_dwordx2 v[154:155], v15, s[8:11], s31 offen offset:2048
L_c2:
  s_cmp_ge_u32 s16, 2
  s_cbranch_scc1 AT_3_nf
  s_lshl_b32 s33, s16, 2
  s_sub_u32 s33, 8, s33
  s_mul_i32 s34, s33, 2560
  v_lshlrev_b32 v136, 3, v6
  v_add_u32 v136, s34, v136
  v_lshlrev_b32 v137, 2, v6
  v_add_u32 v137, s34, v137
  ds_read_b128 v[16:19], v136
  ds_read_b128 v[20:23], v136 offset:1024
  ds_read_b64 v[24:25], v137 offset:2048
  v_mov_b32 v28, 0
  v_mov_b32 v29, 0
  v_mov_b32 v30, 0
  v_mov_b32 v31, 0
  s_mov_b32 s35, s18
  s_waitcnt lgkmcnt(0)
AT_3_fl:
  s_mul_i32 s34, s35, 2560
  v_add_u32 v136, s34, v1
  v_lshrrev_b32 v137, 1, v1
  v_add_u32 v137, s34, v137
  ds_write_b128 v136, v[16:19]
  ds_write_b128 v136, v[20:23] offset:1024
  ds_write_b64 v137, v[24:25] offset:2048
  s_mul_i32 s34, s35, 3072
  v_add_u32 v138, s34, v1
  ds_write_b128 v138, v[28:31] offset:30720
  ds_write_b128 v138, v[28:31] offset:31744
  ds_write_b128 v138, v[28:31] offset:32768
  s_add_u32 s35, s35, 4
  s_cmp_lt_u32 s35, s33
  s_cbranch_scc1 AT_3_fl
  s_waitcnt lgkmcnt(0)
  s_barrier
AT_3_nf:
  ds_read_b128 a[28:31], v130 offset:17920
  ds_read_b64 a[86:87], v131 offset:19968
  ds_read_b128 a[24:27], v130 offset:15360
  ds_read_b64 a[84:85], v131 offset:17408
  ds_read_b128 a[20:23], v130 offset:12800
  ds_read_b64 a[82:83], v131 offset:14848
  ds_read_b128 a[16:19], v130 offset:10240
  ds_read_b64 a[80:81], v131 offset:12288
  ds_read_b128 a[12:15], v130 offset:7680
  ds_read_b64 a[78:79], v131 offset:9728
  ds_read_b128 a[8:11], v130 offset:5120
  ds_read_b64 a[76:77], v131 offset:7168
  ds_read_b128 a[4:7], v130 offset:2560
  ds_read_b64 a[74:75], v131 offset:4608
  ds_read_b128 a[0:3], v130 offset:0
  ds_read_b64 a[72:73], v131 offset:2048
  s_waitcnt lgkmcnt(14)
  v_mfma_f32_32x32x16_bf16 v[16:31], a[28:31], v[216:219], v[96:111]
  v_mfma_f32_32x32x8_bf16 v[16:31], a[86:87], v[228:229], v[16:31]
  s_waitcnt lgkmcnt(12)
  v_mfma_f32_32x32x16_bf16 v[32:47], a[24:27], v[216:219], v[96:111]
  v_mfma_f32_32x32x8_bf16 v[32:47], a[84:85], v[228:229], v[32:47]
  s_waitcnt lgkmcnt(10)
  v_mfma_f32_32x32x16_bf16 v[48:63], a[20:23], v[216:219], v[96:111]
  s_nop 6
  v_exp_f32 v16, v16
  v_exp_f32 v17, v17
  v_exp_f32 v18, v18
  v_exp_f32 v19, v19
  v_cvt_pk_bf16_f32 v200, v16, v17
  s_add_u32 s29, s48, 4456448
  buffer_load_dwordx4 a[160:163], v1, s[8:11], s29 offen offset:0 sc1
  v_exp_f32 v20, v20
  v_exp_f32 v21, v21
  v_cvt_pk_bf16_f32 v201, v18, v19
  v_exp_f32 v22, v22
  v_exp_f32 v23, v23
  v_cvt_pk_bf16_f32 v202, v20, v21
  buffer_load_dwordx4 a[164:167], v1, s[8:11], s29 offen offset:1024 sc1
  v_mfma_f32_32x32x8_bf16 v[48:63], a[82:83], v[228:229], v[48:63]
  v_exp_f32 v24, v24
  v_exp_f32 v25, v25
  v_cvt_pk_bf16_f32 v203, v22, v23
  v_exp_f32 v26, v26
  v_exp_f32 v27, v27
  v_cvt_pk_bf16_f32 v204, v24, v25
  v_exp_f32 v28, v28
  v_exp_f32 v29, v29
  v_cvt_pk_bf16_f32 v205, v26, v27
  v_exp_f32 v30, v30
  v_exp_f32 v31, v31
  v_cvt_pk_bf16_f32 v206, v28, v29
  buffer_load_dwordx4 a[168:171], v1, s[8:11], s29 offen offset:2048 sc1
  v_cvt_pk_bf16_f32 v207, v30, v31
  ds_read_b128 a[64:67], v130 offset:18944
  s_lshr_b32 s33, s18, 1
  s_add_u32 s23, s33, s16
  s_lshl_b32 s33, s23, 13
  s_mul_i32 s24, s19, 917504
  s_add_u32 s24, s24, s33
  s_lshl_b32 s33, s17, 9
  s_add_u32 s24, s24, s33
  s_and_b32 s33, s18, 1
  s_lshl_b32 s33, s33, 8
  s_add_u32 s24, s24, s33
  s_add_u32 s24, s24, 638976
  v_lshlrev_b32 v225, 7, v5
  v_mov_b32 v224, s25
  s_mov_b64 exec, 3
  buffer_load_dword v224, v225, s[8:11], s24 offen sc1
  s_mov_b64 exec, -1
  s_waitcnt lgkmcnt(9)
  v_mfma_f32_32x32x16_bf16 v[16:31], a[16:19], v[216:219], v[96:111]
  v_exp_f32 v32, v32
  v_exp_f32 v33, v33
  v_exp_f32 v34, v34
  v_exp_f32 v35, v35
  v_cvt_pk_bf16_f32 v192, v32, v33
  buffer_load_dwordx4 a[172:175], v1, s[8:11], s29 offen offset:3072 sc1
  v_exp_f32 v36, v36
  v_exp_f32 v37, v37
  v_cvt_pk_bf16_f32 v193, v34, v35
  v_exp_f32 v38, v38
  v_exp_f32 v39, v39
  v_cvt_pk_bf16_f32 v194, v36, v37
  s_add_u32 s29, s48, 4460544
  buffer_load_dwordx4 a[176:179], v1, s[8:11], s29 offen offset:0 sc1
  v_mfma_f32_32x32x8_bf16 v[16:31], a[80:81], v[228:229], v[16:31]
  v_exp_f32 v40, v40
  v_exp_f32 v41, v41
  v_cvt_pk_bf16_f32 v195, v38, v39
  v_exp_f32 v42, v42
  v_exp_f32 v43, v43
  v_cvt_pk_bf16_f32 v196, v40, v41
  v_exp_f32 v44, v44
  v_exp_f32 v45, v45
  v_cvt_pk_bf16_f32 v197, v42, v43
  v_exp_f32 v46, v46
  v_exp_f32 v47, v47
  v_cvt_pk_bf16_f32 v198, v44, v45
  buffer_load_dwordx4 a[180:183], v1, s[8:11], s29 offen offset:1024 sc1
  v_cvt_pk_bf16_f32 v199, v46, v47
  ds_read_b128 a[60:63], v130 offset:16384
  s_waitcnt lgkmcnt(8)
  v_mfma_f32_32x32x16_bf16 v[32:47], a[12:15], v[216:219], v[96:111]
  v_exp_f32 v48, v48
  v_exp_f32 v49, v49
  v_exp_f32 v50, v50
  v_exp_f32 v51, v51
  v_cvt_pk_bf16_f32 v184, v48, v49
  buffer_load_dwordx4 a[184:187], v1, s[8:11], s29 offen offset:2048 sc1
  v_exp_f32 v52, v52
  v_exp_f32 v53, v53
  v_cvt_pk_bf16_f32 v185, v50, v51
  v_exp_f32 v54, v54
  v_exp_f32 v55, v55
  v_cvt_pk_bf16_f32 v186, v52, v53
  buffer_load_dwordx4 a[188:191], v1, s[8:11], s29 offen offset:3072 sc1
  v_mfma_f32_32x32x8_bf16 v[32:47], a[78:79], v[228:229], v[32:47]
  v_exp_f32 v56, v56
  v_exp_f32 v57, v57
  v_cvt_pk_bf16_f32 v187, v54, v55
  v_exp_f32 v58, v58
  v_exp_f32 v59, v59
  v_cvt_pk_bf16_f32 v188, v56, v57
  v_exp_f32 v60, v60
  v_exp_f32 v61, v61
  v_cvt_pk_bf16_f32 v189, v58, v59
  v_exp_f32 v62, v62
  v_exp_f32 v63, v63
  v_cvt_pk_bf16_f32 v190, v60, v61
  s_add_u32 s29, s48, 4464640
  buffer_load_dwordx4 a[192:195], v1, s[8:11], s29 offen offset:0 sc1
  v_cvt_pk_bf16_f32 v191, v62, v63
  ds_read_b128 a[56:59], v130 offset:13824
  s_waitcnt lgkmcnt(7)
  v_mfma_f32_32x32x16_bf16 v[48:63], a[8:11], v[216:219], v[96:111]
  v_exp_f32 v16, v16
  v_exp_f32 v17, v17
  v_exp_f32 v18, v18
  v_exp_f32 v19, v19
  v_cvt_pk_bf16_f32 v176, v16, v17
  buffer_load_dwordx4 a[196:199], v1, s[8:11], s29 offen offset:1024 sc1
  v_exp_f32 v20, v20
  v_exp_f32 v21, v21
  v_cvt_pk_bf16_f32 v177, v18, v19
  v_exp_f32 v22, v22
  v_exp_f32 v23, v23
  v_cvt_pk_bf16_f32 v178, v20, v21
  buffer_load_dwordx4 a[200:203], v1, s[8:11], s29 offen offset:2048 sc1
  v_mfma_f32_32x32x8_bf16 v[48:63], a[76:77], v[228:229], v[48:63]
  v_exp_f32 v24, v24
  v_exp_f32 v25, v25
  v_cvt_pk_bf16_f32 v179, v22, v23
  v_exp_f32 v26, v26
  v_exp_f32 v27, v27
  v_cvt_pk_bf16_f32 v180, v24, v25
  v_exp_f32 v28, v28
  v_exp_f32 v29, v29
  v_cvt_pk_bf16_f32 v181, v26, v27
  v_exp_f32 v30, v30
  v_exp_f32 v31, v31
  v_cvt_pk_bf16_f32 v182, v28, v29
  buffer_load_dwordx4 a[204:207], v1, s[8:11], s29 offen offset:3072 sc1
  v_cvt_pk_bf16_f32 v183, v30, v31
  ds_read_b128 a[52:55], v130 offset:11264
  s_cmp_lg_u32 s26, 0
  s_cbranch_scc1 AT_3_nv
  s_cmp_lt_u32 s23, 2
  s_cbranch_scc1 AT_3_nv
  s_waitcnt vmcnt(9)
  v_cmp_ne_u32 vcc, s25, v224
  s_cbranch_vccz PL_5_k
  s_mov_b32 s32, 0x40000
  s_mov_b64 exec, 3
PL_5_p:
  buffer_load_dword v224, v225, s[8:11], s24 offen sc1
  s_sub_u32 s32, s32, 1
  s_cbranch_scc1 PL_5_d
  s_waitcnt vmcnt(0)
  v_cmp_ne_u32 vcc, s25, v224
  s_cbranch_vccnz PL_5_p
PL_5_d:
  s_mov_b64 exec, -1
PL_5_k:
  s_mul_i32 s34, s18, 6144
  s_add_u32 s33, s45, s34
  s_add_u32 s28, s33, -24576
  s_add_u32 m0, s34, 30720
  s_nop 0
  buffer_load_dwordx4 v1, s[8:11], s28 offen offset:0 sc1 lds
  buffer_load_dwordx4 v1, s[8:11], s28 offen offset:1024 sc1 lds
  buffer_load_dwordx4 v1, s[8:11], s28 offen offset:2048 sc1 lds
  buffer_load_dwordx4 v1, s[8:11], s28 offen offset:3072 sc1 lds
  s_add_u32 s28, s33, -20480
  s_add_u32 m0, s34, 34816
  s_nop 0
  buffer_load_dwordx4 v1, s[8:11], s28 offen offset:0 sc1 lds
  buffer_load_dwordx4 v1, s[8:11], s28 offen offset:1024 sc1 lds
AT_3_nv:
  s_waitcnt lgkmcnt(6)
  v_mfma_f32_32x32x16_bf16 v[16:31], a[4:7], v[216:219], v[96:111]
  v_exp_f32 v32, v32
  v_exp_f32 v33, v33
  v_exp_f32 v34, v34
  v_exp_f32 v35, v35
  v_cvt_pk_bf16_f32 v168, v32, v33
  s_add_u32 s29, s48, 4468736
  buffer_load_dwordx4 a[208:211], v1, s[8:11], s29 offen offset:0 sc1
  v_exp_f32 v36, v36
  v_exp_f32 v37, v37
  v_cvt_pk_bf16_f32 v169, v34, v35
  v_exp_f32 v38, v38
  v_exp_f32 v39, v39
  v_cvt_pk_bf16_f32 v170, v36, v37
  buffer_load_dwordx4 a[212:215], v1, s[8:11], s29 offen offset:1024 sc1
  v_mfma_f32_32x32x8_bf16 v[16:31], a[74:75], v[228:229], v[16:31]
  v_exp_f32 v40, v40
  v_exp_f32 v41, v41
  v_cvt_pk_bf16_f32 v171, v38, v39
  v_exp_f32 v42, v42
  v_exp_f32 v43, v43
  v_cvt_pk_bf16_f32 v172, v40, v41
  v_exp_f32 v44, v44
  v_exp_f32 v45, v45
  v_cvt_pk_bf16_f32 v173, v42, v43
  v_exp_f32 v46, v46
  v_exp_f32 v47, v47
  v_cvt_pk_bf16_f32 v174, v44, v45
  buffer_load_dwordx4 a[216:219], v1, s[8:11], s29 offen offset:2048 sc1
  v_cvt_pk_bf16_f32 v175, v46, v47
  ds_read_b128 a[48:51], v130 offset:8704
  v_cndmask_b32 v32, v128, v135, s[56:57]
  v_cndmask_b32 v33, v128, v135, s[58:59]
  v_cndmask_b32 v34, v128, v135, s[60:61]
  v_cndmask_b32 v35, v128, v135, s[62:63]
  v_cndmask_b32 v36, v128, v135, s[64:65]
  v_cndmask_b32 v37, v128, v135, s[66:67]
  v_cndmask_b32 v38, v128, v135, s[68:69]
  v_cndmask_b32 v39, v128, v135, s[70:71]
  v_cndmask_b32 v40, v128, v135, s[72:73]
  v_cndmask_b32 v41, v128, v135, s[74:75]
  v_cndmask_b32 v42, v128, v135, s[76:77]
  v_cndmask_b32 v43, v128, v135, s[78:79]
  v_cndmask_b32 v44, v128, v135, s[80:81]
  v_cndmask_b32 v45, v128, v135, s[82:83]
  v_cndmask_b32 v46, v128, v135, s[84:85]
  v_cndmask_b32 v47, v128, v135, s[86:87]
  s_waitcnt lgkmcnt(5)
  s_nop 0
  v_mfma_f32_32x32x16_bf16 v[32:47], a[0:3], v[216:219], v[32:47]
  v_exp_f32 v48, v48
  v_mov_b32 v96, v129
  v_exp_f32 v49, v49
  v_mov_b32 v97, v129
  v_exp_f32 v50, v50
  v_mov_b32 v98, v129
  v_exp_f32 v51, v51
  v_cvt_pk_bf16_f32 v160, v48, v49
  v_mov_b32 v99, v129
  buffer_load_dwordx4 a[220:223], v1, s[8:11], s29 offen offset:3072 sc1
  v_exp_f32 v52, v52
  v_mov_b32 v100, v129
  v_exp_f32 v53, v53
  v_cvt_pk_bf16_f32 v161, v50, v51
  v_mov_b32 v101, v129
  v_exp_f32 v54, v54
  v_mov_b32 v102, v129
  v_exp_f32 v55, v55
  v_cvt_pk_bf16_f32 v162, v52, v53
  v_mov_b32 v103, v129
  s_add_u32 s29, s48, 4472832
  buffer_load_dwordx4 a[224:227], v1, s[8:11], s29 offen offset:0 sc1
  v_mfma_f32_32x32x8_bf16 v[32:47], a[72:73], v[228:229], v[32:47]
  v_exp_f32 v56, v56
  v_mov_b32 v104, v129
  v_exp_f32 v57, v57
  v_cvt_pk_bf16_f32 v163, v54, v55
  v_mov_b32 v105, v129
  v_exp_f32 v58, v58
  v_mov_b32 v106, v129
  v_exp_f32 v59, v59
  v_cvt_pk_bf16_f32 v164, v56, v57
  v_mov_b32 v107, v129
  v_exp_f32 v60, v60
  v_mov_b32 v108, v129
  v_exp_f32 v61, v61
  v_cvt_pk_bf16_f32 v165, v58, v59
  v_mov_b32 v109, v129
  v_exp_f32 v62, v62
  v_mov_b32 v110, v129
  v_exp_f32 v63, v63
  v_cvt_pk_bf16_f32 v166, v60, v61
  v_mov_b32 v111, v129
  buffer_load_dwordx4 a[228:231], v1, s[8:11], s29 offen offset:1024 sc1
  v_cvt_pk_bf16_f32 v167, v62, v63
  ds_read_b128 a[44:47], v130 offset:6144
  s_waitcnt lgkmcnt(5)
  v_mfma_f32_32x32x16_bf16 v[48:63], a[64:67], v[220:223], v[96:111]
  v_exp_f32 v16, v16
  v_exp_f32 v17, v17
  v_exp_f32 v18, v18
  v_exp_f32 v19, v19
  v_cvt_pk_bf16_f32 v152, v16, v17
  v_exp_f32 v20, v20
  v_exp_f32 v21, v21
  v_cvt_pk_bf16_f32 v153, v18, v19
  v_exp_f32 v22, v22
  v_exp_f32 v23, v23
  v_cvt_pk_bf16_f32 v154, v20, v21
  v_mfma_f32_32x32x8_bf16 v[48:63], a[86:87], v[230:231], v[48:63]
  v_exp_f32 v24, v24
  v_exp_f32 v25, v25
  v_cvt_pk_bf16_f32 v155, v22, v23
  v_exp_f32 v26, v26
  v_exp_f32 v27, v27
  v_cvt_pk_bf16_f32 v156, v24, v25
  v_exp_f32 v28, v28
  v_exp_f32 v29, v29
  v_cvt_pk_bf16_f32 v157, v26, v27
  v_exp_f32 v30, v30
  v_exp_f32 v31, v31
  v_cvt_pk_bf16_f32 v158, v28, v29
  v_cvt_pk_bf16_f32 v159, v30, v31
  ds_read_b128 a[40:43], v130 offset:3584
  s_waitcnt lgkmcnt(5)
  v_mfma_f32_32x32x16_bf16 v[16:31], a[60:63], v[220:223], v[96:111]
  v_exp_f32 v32, v32
  v_exp_f32 v33, v33
  v_exp_f32 v34, v34
  v_exp_f32 v35, v35
  v_cvt_pk_bf16_f32 v144, v32, v33
  v_exp_f32 v36, v36
  v_exp_f32 v37, v37
  v_cvt_pk_bf16_f32 v145, v34, v35
  v_exp_f32 v38, v38
  v_exp_f32 v39, v39
  v_cvt_pk_bf16_f32 v146, v36, v37
  v_mfma_f32_32x32x8_bf16 v[16:31], a[84:85], v[230:231], v[16:31]
  v_exp_f32 v40, v40
  v_exp_f32 v41, v41
  v_cvt_pk_bf16_f32 v147, v38, v39
  v_exp_f32 v42, v42
  v_exp_f32 v43, v43
  v_cvt_pk_bf16_f32 v148, v40, v41
  v_exp_f32 v44, v44
  v_exp_f32 v45, v45
  v_cvt_pk_bf16_f32 v149, v42, v43
  v_exp_f32 v46, v46
  v_exp_f32 v47, v47
  v_cvt_pk_bf16_f32 v150, v44, v45
  v_cvt_pk_bf16_f32 v151, v46, v47
  ds_read_b128 a[36:39], v130 offset:1024
  s_cmp_lg_u32 s26, 0
  s_cbranch_scc1 AT_3_nb
  s_waitcnt vmcnt(0)
  s_barrier
AT_3_nb:
  s_waitcnt lgkmcnt(5)
  v_mfma_f32_32x32x16_bf16 v[32:47], a[56:59], v[220:223], v[96:111]
  v_exp_f32 v48, v48
  v_exp_f32 v49, v49
  ds_read_b64_tr_b16 a[116:117], v132 offset:21504
  ds_read_b64_tr_b16 a[118:119], v132 offset:21888
  v_exp_f32 v50, v50
  v_exp_f32 v51, v51
  v_cvt_pk_bf16_f32 v112, v48, v49
  buffer_load_dwordx4 a[232:235], v1, s[8:11], s29 offen offset:2048 sc1
  v_exp_f32 v52, v52
  v_exp_f32 v53, v53
  v_cvt_pk_bf16_f32 v113, v50, v51
  ds_read_b64_tr_b16 a[120:121], v132 offset:22272
  ds_read_b64_tr_b16 a[122:123], v132 offset:22656
  v_exp_f32 v54, v54
  v_exp_f32 v55, v55
  v_cvt_pk_bf16_f32 v114, v52, v53
  buffer_load_dwordx4 a[236:239], v1, s[8:11], s29 offen offset:3072 sc1
  v_mfma_f32_32x32x8_bf16 v[32:47], a[82:83], v[230:231], v[32:47]
  v_exp_f32 v56, v56
  v_exp_f32 v57, v57
  v_cvt_pk_bf16_f32 v115, v54, v55
  ds_read_b64_tr_b16 a[148:149], v132 offset:23040
  ds_read_b64_tr_b16 a[150:151], v132 offset:23424
  v_exp_f32 v58, v58
  v_exp_f32 v59, v59
  v_cvt_pk_bf16_f32 v116, v56, v57
  v_exp_f32 v60, v60
  v_exp_f32 v61, v61
  v_cvt_pk_bf16_f32 v117, v58, v59
  ds_read_b64_tr_b16 a[152:153], v132 offset:23808
  ds_read_b64_tr_b16 a[154:155], v132 offset:24192
  v_exp_f32 v62, v62
  v_exp_f32 v63, v63
  v_cvt_pk_bf16_f32 v118, v60, v61
  s_add_u32 s29, s48, 4476928
  buffer_load_dwordx4 a[240:243], v1, s[8:11], s29 offen offset:0 sc1
  v_cvt_pk_bf16_f32 v119, v62, v63
  s_waitcnt lgkmcnt(12)
  v_mfma_f32_32x32x16_bf16 v[48:63], a[52:55], v[220:223], v[96:111]
  v_exp_f32 v16, v16
  v_exp_f32 v17, v17
  ds_read_b64_tr_b16 a[108:109], v132 offset:18432
  ds_read_b64_tr_b16 a[110:111], v132 offset:18816
  v_exp_f32 v18, v18
  v_mfma_f32_32x32x8_bf16 v[48:63], a[80:81], v[230:231], v[48:63]
  v_exp_f32 v19, v19
  v_cvt_pk_bf16_f32 v120, v16, v17
  v_exp_f32 v20, v20
  v_exp_f32 v21, v21
  v_cvt_pk_bf16_f32 v121, v18, v19
  ds_read_b64_tr_b16 a[112:113], v132 offset:19200
  ds_read_b64_tr_b16 a[114:115], v132 offset:19584
  s_waitcnt lgkmcnt(8)
  v_mfma_f32_32x32x16_bf16 v[64:79], a[116:119], v[200:203], v[64:79]
  v_exp_f32 v22, v22
  v_exp_f32 v23, v23
  v_cvt_pk_bf16_f32 v122, v20, v21
  buffer_load_dwordx4 a[244:247], v1, s[8:11], s29 offen offset:1024 sc1
  v_exp_f32 v24, v24
  s_waitcnt lgkmcnt(4)
  v_mfma_f32_32x32x16_bf16 v[80:95], a[148:151], v[112:115], v[80:95]
  v_exp_f32 v25, v25
  v_cvt_pk_bf16_f32 v123, v22, v23
  ds_read_b64_tr_b16 a[140:141], v132 offset:19968
  ds_read_b64_tr_b16 a[142:143], v132 offset:20352
  v_exp_f32 v26, v26
  v_exp_f32 v27, v27
  v_cvt_pk_bf16_f32 v124, v24, v25
  v_mfma_f32_32x32x16_bf16 v[64:79], a[120:123], v[204:207], v[64:79]
  v_exp_f32 v28, v28
  v_exp_f32 v29, v29
  v_cvt_pk_bf16_f32 v125, v26, v27
  ds_read_b64_tr_b16 a[144:145], v132 offset:20736
  ds_read_b64_tr_b16 a[146:147], v132 offset:21120
  v_mfma_f32_32x32x16_bf16 v[80:95], a[152:155], v[116:119], v[80:95]
  v_exp_f32 v30, v30
  v_exp_f32 v31, v31
  v_cvt_pk_bf16_f32 v126, v28, v29
  buffer_load_dwordx4 a[248:251], v1, s[8:11], s29 offen offset:2048 sc1
  v_cvt_pk_bf16_f32 v127, v30, v31
  v_mfma_f32_32x32x16_bf16 v[16:31], a[48:51], v[220:223], v[96:111]
  v_exp_f32 v32, v32
  v_exp_f32 v33, v33
  ds_read_b64_tr_b16 a[100:101], v132 offset:15360
  ds_read_b64_tr_b16 a[102:103], v132 offset:15744
  v_exp_f32 v34, v34
  v_mfma_f32_32x32x8_bf16 v[16:31], a[78:79], v[230:231], v[16:31]
  v_exp_f32 v35, v35
  v_cvt_pk_bf16_f32 v112, v32, v33
  v_exp_f32 v36, v36
  v_exp_f32 v37, v37
  v_cvt_pk_bf16_f32 v113, v34, v35
  ds_read_b64_tr_b16 a[104:105], v132 offset:16128
  ds_read_b64_tr_b16 a[106:107], v132 offset:16512
  s_waitcnt lgkmcnt(8)
  v_mfma_f32_32x32x16_bf16 v[64:79], a[108:111], v[192:195], v[64:79]
  v_exp_f32 v38, v38
  v_exp_f32 v39, v39
  v_cvt_pk_bf16_f32 v114, v36, v37
  buffer_load_dwordx4 a[252:255], v1, s[8:11], s29 offen offset:3072 sc1
  v_exp_f32 v40, v40
  s_waitcnt lgkmcnt(4)
  v_mfma_f32_32x32x16_bf16 v[80:95], a[140:143], v[120:123], v[80:95]
  v_exp_f32 v41, v41
  v_cvt_pk_bf16_f32 v115, v38, v39
  ds_read_b64_tr_b16 a[132:133], v132 offset:16896
  ds_read_b64_tr_b16 a[134:135], v132 offset:17280
  v_exp_f32 v42, v42
  v_exp_f32 v43, v43
  v_cvt_pk_bf16_f32 v116, v40, v41
  v_mfma_f32_32x32x16_bf16 v[64:79], a[112:115], v[196:199], v[64:79]
  v_exp_f32 v44, v44
  v_exp_f32 v45, v45
  v_cvt_pk_bf16_f32 v117, v42, v43
  ds_read_b64_tr_b16 a[136:137], v132 offset:17664
  ds_read_b64_tr_b16 a[138:139], v132 offset:18048
  v_mfma_f32_32x32x16_bf16 v[80:95], a[144:147], v[124:127], v[80:95]
  v_exp_f32 v46, v46
  v_exp_f32 v47, v47
  v_cvt_pk_bf16_f32 v118, v44, v45
  s_add_u32 s29, s48, 4481024
  buffer_load_dwordx4 v[140:143], v1, s[8:11], s29 offen offset:0 sc1
  v_cvt_pk_bf16_f32 v119, v46, v47
  v_mfma_f32_32x32x16_bf16 v[32:47], a[44:47], v[220:223], v[96:111]
  v_exp_f32 v48, v48
  v_exp_f32 v49, v49
  ds_read_b64_tr_b16 a[92:93], v132 offset:12288
  ds_read_b64_tr_b16 a[94:95], v132 offset:12672
  v_exp_f32 v50, v50
  v_mfma_f32_32x32x8_bf16 v[32:47], a[76:77], v[230:231], v[32:47]
  v_exp_f32 v51, v51
  v_cvt_pk_bf16_f32 v120, v48, v49
  v_exp_f32 v52, v52
  v_exp_f32 v53, v53
  v_cvt_pk_bf16_f32 v121, v50, v51
  ds_read_b64_tr_b16 a[96:97], v132 offset:13056
  ds_read_b64_tr_b16 a[98:99], v132 offset:13440
  s_waitcnt lgkmcnt(8)
  v_mfma_f32_32x32x16_bf16 v[64:79], a[100:103], v[184:187], v[64:79]
  v_exp_f32 v54, v54
  v_exp_f32 v55, v55
  v_cvt_pk_bf16_f32 v122, v52, v53
  s_add_u32 s28, s40, 0
  s_add_u32 m0, s41, 81920
  s_nop 0
  buffer_load_dwordx4 v1, s[8:11], s28 offen offset:0 sc1 lds
  v_exp_f32 v56, v56
  s_waitcnt lgkmcnt(4)
  v_mfma_f32_32x32x16_bf16 v[80:95], a[132:135], v[112:115], v[80:95]
  v_exp_f32 v57, v57
  v_cvt_pk_bf16_f32 v123, v54, v55
  ds_read_b64_tr_b16 a[124:125], v132 offset:13824
  ds_read_b64_tr_b16 a[126:127], v132 offset:14208
  v_exp_f32 v58, v58
  v_exp_f32 v59, v59
  v_cvt_pk_bf16_f32 v124, v56, v57
  v_mfma_f32_32x32x16_bf16 v[64:79], a[104:107], v[188:191], v[64:79]
  v_exp_f32 v60, v60
  v_exp_f32 v61, v61
  v_cvt_pk_bf16_f32 v125, v58, v59
  ds_read_b64_tr_b16 a[128:129], v132 offset:14592
  ds_read_b64_tr_b16 a[130:131], v132 offset:14976
  v_mfma_f32_32x32x16_bf16 v[80:95], a[136:139], v[116:119], v[80:95]
  v_exp_f32 v62, v62
  v_exp_f32 v63, v63
  v_cvt_pk_bf16_f32 v126, v60, v61
  buffer_load_dwordx4 v1, s[8:11], s28 offen offset:1024 sc1 lds
  v_cvt_pk_bf16_f32 v127, v62, v63
  v_mfma_f32_32x32x16_bf16 v[48:63], a[40:43], v[220:223], v[96:111]
  v_exp_f32 v16, v16
  v_exp_f32 v17, v17
  ds_read_b64_tr_b16 a[116:117], v132 offset:9216
  ds_read_b64_tr_b16 a[118:119], v132 offset:9600
  v_exp_f32 v18, v18
  v_mfma_f32_32x32x8_bf16 v[48:63], a[74:75], v[230:231], v[48:63]
  v_exp_f32 v19, v19
  v_cvt_pk_bf16_f32 v112, v16, v17
  v_exp_f32 v20, v20
  v_exp_f32 v21, v21
  v_cvt_pk_bf16_f32 v113, v18, v19
  ds_read_b64_tr_b16 a[120:121], v132 offset:9984
  ds_read_b64_tr_b16 a[122:123], v132 offset:10368
  s_waitcnt lgkmcnt(8)
  v_mfma_f32_32x32x16_bf16 v[64:79], a[92:95], v[176:179], v[64:79]
  v_exp_f32 v22, v22
  v_exp_f32 v23, v23
  v_cvt_pk_bf16_f32 v114, v20, v21
  buffer_load_dwordx4 v1, s[8:11], s28 offen offset:2048 sc1 lds
  v_exp_f32 v24, v24
  s_waitcnt lgkmcnt(4)
  v_mfma_f32_32x32x16_bf16 v[80:95], a[124:127], v[120:123], v[80:95]
  v_exp_f32 v25, v25
  v_cvt_pk_bf16_f32 v115, v22, v23
  ds_read_b64_tr_b16 a[148:149], v132 offset:10752
  ds_read_b64_tr_b16 a[150:151], v132 offset:11136
  v_exp_f32 v26, v26
  v_exp_f32 v27, v27
  v_cvt_pk_bf16_f32 v116, v24, v25
  v_mfma_f32_32x32x16_bf16 v[64:79], a[96:99], v[180:183], v[64:79]
  v_exp_f32 v28, v28
  v_exp_f32 v29, v29
  v_cvt_pk_bf16_f32 v117, v26, v27
  ds_read_b64_tr_b16 a[152:153], v132 offset:11520
  ds_read_b64_tr_b16 a[154:155], v132 offset:11904
  v_mfma_f32_32x32x16_bf16 v[80:95], a[128:131], v[124:127], v[80:95]
  v_exp_f32 v30, v30
  v_exp_f32 v31, v31
  v_cvt_pk_bf16_f32 v118, v28, v29
  buffer_load_dwordx4 v1, s[8:11], s28 offen offset:3072 sc1 lds
  v_cvt_pk_bf16_f32 v119, v30, v31
  v_cndmask_b32 v16, v129, v135, s[56:57]
  v_cndmask_b32 v17, v129, v135, s[58:59]
  v_cndmask_b32 v18, v129, v135, s[60:61]
  v_cndmask_b32 v19, v129, v135, s[62:63]
  v_cndmask_b32 v20, v129, v135, s[64:65]
  v_cndmask_b32 v21, v129, v135, s[66:67]
  v_cndmask_b32 v22, v129, v135, s[68:69]
  v_cndmask_b32 v23, v129, v135, s[70:71]
  v_cndmask_b32 v24, v129, v135, s[72:73]
  v_cndmask_b32 v25, v129, v135, s[74:75]
  v_cndmask_b32 v26, v129, v135, s[76:77]
  v_cndmask_b32 v27, v129, v135, s[78:79]
  v_cndmask_b32 v28, v129, v135, s[80:81]
  v_cndmask_b32 v29, v129, v135, s[82:83]
  v_cndmask_b32 v30, v129, v135, s[84:85]
  v_cndmask_b32 v31, v129, v135, s[86:87]
  s_nop 1
  v_mfma_f32_32x32x16_bf16 v[16:31], a[36:39], v[220:223], v[16:31]
  v_exp_f32 v32, v32
  v_exp_f32 v33, v33
  ds_read_b64_tr_b16 a[108:109], v132 offset:6144
  ds_read_b64_tr_b16 a[110:111], v132 offset:6528
  v_exp_f32 v34, v34
  v_mfma_f32_32x32x8_bf16 v[16:31], a[72:73], v[230:231], v[16:31]
  v_exp_f32 v35, v35
  v_cvt_pk_bf16_f32 v120, v32, v33
  v_exp_f32 v36, v36
  v_exp_f32 v37, v37
  v_cvt_pk_bf16_f32 v121, v34, v35
  ds_read_b64_tr_b16 a[112:113], v132 offset:6912
  ds_read_b64_tr_b16 a[114:115], v132 offset:7296
  s_waitcnt lgkmcnt(8)
  v_mfma_f32_32x32x16_bf16 v[64:79], a[116:119], v[168:171], v[64:79]
  v_exp_f32 v38, v38
  v_exp_f32 v39, v39
  v_cvt_pk_bf16_f32 v122, v36, v37
  s_add_u32 s28, s40, 4096
  s_add_u32 m0, s41, 86016
  s_nop 0
  buffer_load_dwordx4 v1, s[8:11], s28 offen offset:0 sc1 lds
  v_exp_f32 v40, v40
  s_waitcnt lgkmcnt(4)
  v_mfma_f32_32x32x16_bf16 v[80:95], a[148:151], v[112:115], v[80:95]
  v_exp_f32 v41, v41
  v_cvt_pk_bf16_f32 v123, v38, v39
  ds_read_b64_tr_b16 a[140:141], v132 offset:7680
  ds_read_b64_tr_b16 a[142:143], v132 offset:8064
  v_exp_f32 v42, v42
  v_exp_f32 v43, v43
  v_cvt_pk_bf16_f32 v124, v40, v41
  v_mfma_f32_32x32x16_bf16 v[64:79], a[120:123], v[172:175], v[64:79]
  v_exp_f32 v44, v44
  v_exp_f32 v45, v45
  v_cvt_pk_bf16_f32 v125, v42, v43
  ds_read_b64_tr_b16 a[144:145], v132 offset:8448
  ds_read_b64_tr_b16 a[146:147], v132 offset:8832
  v_mfma_f32_32x32x16_bf16 v[80:95], a[152:155], v[116:119], v[80:95]
  v_exp_f32 v46, v46
  v_exp_f32 v47, v47
  v_cvt_pk_bf16_f32 v126, v44, v45
  s_add_u32 s28, s40, 20480
  s_add_u32 m0, s41, 102400
  s_nop 0
  buffer_load_dwordx4 v1, s[8:11], s28 offen offset:0 sc1 lds
  v_cvt_pk_bf16_f32 v127, v46, v47
  s_waitcnt lgkmcnt(4)
  v_mfma_f32_32x32x16_bf16 v[64:79], a[108:111], v[160:163], v[64:79]
  v_exp_f32 v48, v48
  v_exp_f32 v49, v49
  ds_read_b64_tr_b16 a[100:101], v132 offset:3072
  ds_read_b64_tr_b16 a[102:103], v132 offset:3456
  v_exp_f32 v50, v50
  v_exp_f32 v51, v51
  v_cvt_pk_bf16_f32 v112, v48, v49
  s_waitcnt lgkmcnt(2)
  v_mfma_f32_32x32x16_bf16 v[80:95], a[140:143], v[120:123], v[80:95]
  v_exp_f32 v52, v52
  v_exp_f32 v53, v53
  v_cvt_pk_bf16_f32 v113, v50, v51
  ds_read_b64_tr_b16 a[104:105], v132 offset:3840
  ds_read_b64_tr_b16 a[106:107], v132 offset:4224
  v_exp_f32 v54, v54
  v_exp_f32 v55, v55
  v_cvt_pk_bf16_f32 v114, v52, v53
  buffer_load_dwordx4 v1, s[8:11], s28 offen offset:1024 sc1 lds
  v_mfma_f32_32x32x16_bf16 v[64:79], a[112:115], v[164:167], v[64:79]
  v_exp_f32 v56, v56
  v_exp_f32 v57, v57
  v_cvt_pk_bf16_f32 v115, v54, v55
  ds_read_b64_tr_b16 a[132:133], v132 offset:4608
  ds_read_b64_tr_b16 a[134:135], v132 offset:4992
  v_exp_f32 v58, v58
  v_exp_f32 v59, v59
  v_cvt_pk_bf16_f32 v116, v56, v57
  v_mfma_f32_32x32x16_bf16 v[80:95], a[144:147], v[124:127], v[80:95]
  v_exp_f32 v60, v60
  v_exp_f32 v61, v61
  v_cvt_pk_bf16_f32 v117, v58, v59
  ds_read_b64_tr_b16 a[136:137], v132 offset:5376
  ds_read_b64_tr_b16 a[138:139], v132 offset:5760
  v_exp_f32 v62, v62
  v_exp_f32 v63, v63
  v_cvt_pk_bf16_f32 v118, v60, v61
  buffer_load_dwordx4 v1, s[8:11], s28 offen offset:2048 sc1 lds
  v_cvt_pk_bf16_f32 v119, v62, v63
  s_waitcnt lgkmcnt(4)
  v_mfma_f32_32x32x16_bf16 v[64:79], a[100:103], v[152:155], v[64:79]
  v_exp_f32 v16, v16
  v_exp_f32 v17, v17
  ds_read_b64_tr_b16 a[92:93], v132 offset:0
  ds_read_b64_tr_b16 a[94:95], v132 offset:384
  v_exp_f32 v18, v18
  v_exp_f32 v19, v19
  v_cvt_pk_bf16_f32 v120, v16, v17
  s_waitcnt lgkmcnt(2)
  v_mfma_f32_32x32x16_bf16 v[80:95], a[132:135], v[112:115], v[80:95]
  v_exp_f32 v20, v20
  v_exp_f32 v21, v21
  v_cvt_pk_bf16_f32 v121, v18, v19
  ds_read_b64_tr_b16 a[96:97], v132 offset:768
  ds_read_b64_tr_b16 a[98:99], v132 offset:1152
  v_exp_f32 v22, v22
  v_exp_f32 v23, v23
  v_cvt_pk_bf16_f32 v122, v20, v21
  buffer_load_dwordx4 v1, s[8:11], s28 offen offset:3072 sc1 lds
  v_mfma_f32_32x32x16_bf16 v[64:79], a[104:107], v[156:159], v[64:79]
  v_exp_f32 v24, v24
  v_exp_f32 v25, v25
  v_cvt_pk_bf16_f32 v123, v22, v23
  ds_read_b64_tr_b16 a[124:125], v132 offset:1536
  ds_read_b64_tr_b16 a[126:127], v132 offset:1920
  v_exp_f32 v26, v26
  v_exp_f32 v27, v27
  v_cvt_pk_bf16_f32 v124, v24, v25
  v_mfma_f32_32x32x16_bf16 v[80:95], a[136:139], v[116:119], v[80:95]
  v_exp_f32 v28, v28
  v_exp_f32 v29, v29
  v_cvt_pk_bf16_f32 v125, v26, v27
  ds_read_b64_tr_b16 a[128:129], v132 offset:2304
  ds_read_b64_tr_b16 a[130:131], v132 offset:2688
  v_exp_f32 v30, v30
  v_exp_f32 v31, v31
  v_cvt_pk_bf16_f32 v126, v28, v29
  s_add_u32 s28, s40, 24576
  s_add_u32 m0, s41, 106496
  s_nop 0
  buffer_load_dwordx4 v1, s[8:11], s28 offen offset:0 sc1 lds
  v_cvt_pk_bf16_f32 v127, v30, v31
  s_waitcnt lgkmcnt(4)
  v_mfma_f32_32x32x16_bf16 v[64:79], a[92:95], v[144:147], v[64:79]
  v_mfma_f32_32x32x16_bf16 v[64:79], a[96:99], v[148:151], v[64:79]
  s_waitcnt lgkmcnt(0)
  v_mfma_f32_32x32x16_bf16 v[80:95], a[124:127], v[120:123], v[80:95]
  v_mfma_f32_32x32x16_bf16 v[80:95], a[128:131], v[124:127], v[80:95]
  v_cmp_gt_u32 vcc, 32, v5
  s_nop 7
  v_cndmask_b32 v16, v72, v76, vcc
  v_rcp_f32 v18, v16
  s_nop 0
  v_pk_mul_f32 v[64:65], v[64:65], v[18:19] op_sel_hi:[1,0]
  v_pk_mul_f32 v[66:67], v[66:67], v[18:19] op_sel_hi:[1,0]
  v_pk_mul_f32 v[68:69], v[68:69], v[18:19] op_sel_hi:[1,0]
  v_pk_mul_f32 v[70:71], v[70:71], v[18:19] op_sel_hi:[1,0]
  v_pk_mul_f32 v[72:73], v[72:73], v[18:19] op_sel_hi:[1,0]
  v_pk_mul_f32 v[74:75], v[74:75], v[18:19] op_sel_hi:[1,0]
  v_cvt_pk_bf16_f32 v20, v64, v65
  v_cvt_pk_bf16_f32 v21, v66, v67
  v_cvt_pk_bf16_f32 v22, v68, v69
  v_cvt_pk_bf16_f32 v23, v70, v71
  v_cvt_pk_bf16_f32 v28, v72, v73
  v_cvt_pk_bf16_f32 v29, v74, v75
  v_cndmask_b32 v17, v88, v92, vcc
  v_rcp_f32 v18, v17
  v_add_f32 v16, v16, v17
  v_pk_mul_f32 v[80:81], v[80:81], v[18:19] op_sel_hi:[1,0]
  v_pk_mul_f32 v[82:83], v[82:83], v[18:19] op_sel_hi:[1,0]
  v_pk_mul_f32 v[84:85], v[84:85], v[18:19] op_sel_hi:[1,0]
  v_pk_mul_f32 v[86:87], v[86:87], v[18:19] op_sel_hi:[1,0]
  v_pk_mul_f32 v[88:89], v[88:89], v[18:19] op_sel_hi:[1,0]
  v_pk_mul_f32 v[90:91], v[90:91], v[18:19] op_sel_hi:[1,0]
  v_cvt_pk_bf16_f32 v24, v80, v81
  v_cvt_pk_bf16_f32 v25, v82, v83
  v_cvt_pk_bf16_f32 v26, v84, v85
  v_cvt_pk_bf16_f32 v27, v86, v87
  v_cvt_pk_bf16_f32 v30, v88, v89
  v_cvt_pk_bf16_f32 v31, v90, v91
  v_cmp_nge_f32 vcc, 0x53800000, v16
  s_cbranch_vccnz L_slow
L_attdone:
  buffer_store_dwordx4 v[20:23], v8, s[8:11], s49 offen offset:0 sc1
  buffer_store_dwordx4 v[24:27], v8, s[8:11], s49 offen offset:512 sc1
  s_mov_b32 exec_hi, 0
  buffer_store_dwordx4 v[28:31], v8, s[8:11], s49 offen offset:1024 sc1
  s_mov_b64 exec, -1
  s_mul_i32 s30, s19, 917504
  s_lshl_b32 s31, s16, 13
  s_add_u32 s30, s30, s31
  s_add_u32 s30, s30, 0
  s_add_u32 s30, s30, s22
  v_mov_b32 v14, s25
  s_waitcnt vmcnt(0)
  s_mov_b64 exec, 1
  buffer_store_dword v14, v4, s[8:11], s30 offen sc1
  s_mov_b64 exec, -1
  s_add_u32 s28, s40, 40960
  s_add_u32 m0, s41, 122880
  s_nop 0
  buffer_load_dwordx4 v1, s[8:11], s28 offen offset:0 sc1 lds
  buffer_load_dwordx4 v1, s[8:11], s28 offen offset:1024 sc1 lds
  buffer_load_dwordx4 v1, s[8:11], s28 offen offset:2048 sc1 lds
  buffer_load_dwordx4 v1, s[8:11], s28 offen offset:3072 sc1 lds
  s_add_u32 s28, s40, 45056
  s_add_u32 m0, s41, 126976
  s_nop 0
  buffer_load_dwordx4 v1, s[8:11], s28 offen offset:0 sc1 lds
  s_add_u32 s28, s40, 61440
  s_add_u32 m0, s41, 143360
  s_nop 0
  buffer_load_dwordx4 v1, s[8:11], s28 offen offset:0 sc1 lds
  buffer_load_dwordx4 v1, s[8:11], s28 offen offset:1024 sc1 lds
  buffer_load_dwordx4 v1, s[8:11], s28 offen offset:2048 sc1 lds
  buffer_load_dwordx4 v1, s[8:11], s28 offen offset:3072 sc1 lds
  s_add_u32 s28, s40, 65536
  s_add_u32 m0, s41, 147456
  s_nop 0
  buffer_load_dwordx4 v1, s[8:11], s28 offen offset:0 sc1 lds
  s_mul_i32 s33, s19, 2621440
  s_lshl_b32 s35, s16, 3
  s_lshl_b32 s34, s21, 2
  s_add_u32 s35, s35, s34
  s_mul_i32 s35, s35, 20480
  s_add_u32 s33, s33, s35
  s_mul_i32 s35, s18, 5120
  s_add_u32 s33, s33, s35
  s_add_u32 s31, s18, 1
  s_and_b32 s31, s31, 3
  s_mul_i32 s31, s31, 20480
  s_add_u32 s31, s31, s33
  s_add_u32 s44, s31, 35901440
  s_add_u32 s31, s18, 2
  s_and_b32 s31, s31, 3
  s_mul_i32 s31, s31, 20480
  s_add_u32 s31, s31, s33
  s_add_u32 s45, s31, 35901440
  s_add_u32 s31, s18, 3
  s_and_b32 s31, s31, 3
  s_mul_i32 s31, s31, 20480
  s_add_u32 s31, s31, s33
  s_add_u32 s46, s31, 35901440
  s_add_u32 s31, s18, 4
  s_and_b32 s31, s31, 3
  s_mul_i32 s31, s31, 20480
  s_add_u32 s31, s31, s33
  s_add_u32 s47, s31, 35901440
  s_add_u32 s48, s44, 4096
  s_add_u32 s49, s45, 4096
  s_add_u32 s50, s46, 4096
  s_add_u32 s51, s47, 4096
  s_mul_i32 s24, s19, 917504
  s_lshl_b32 s31, s16, 13
  s_add_u32 s24, s24, s31
  s_add_u32 s24, s24, 0
  s_lshl_b32 s31, s21, 8
  s_add_u32 s24, s24, s31
  s_lshl_b32 s31, s18, 11
  s_add_u32 s24, s24, s31
  v_and_b32 v225, 3, v5
  v_lshlrev_b32 v225, 9, v225
  v_bfe_u32 v224, v5, 2, 1
  v_lshl_add_u32 v225, v224, 7, v225
  v_mov_b32 v224, s25
  s_mov_b64 exec, 0xff
  buffer_load_dword v224, v225, s[8:11], s24 offen sc1
  s_mov_b64 exec, -1
  s_waitcnt vmcnt(0)
  v_cmp_ne_u32 vcc, s25, v224
  s_cbranch_vccz PL_6_k
  s_mov_b32 s32, 0x40000
  s_mov_b64 exec, 0xff
PL_6_p:
  buffer_load_dword v224, v225, s[8:11], s24 offen sc1
  s_sub_u32 s32, s32, 1
  s_cbranch_scc1 PL_6_d
  s_waitcnt vmcnt(0)
  v_cmp_ne_u32 vcc, s25, v224
  s_cbranch_vccnz PL_6_p
PL_6_d:
  s_mov_b64 exec, -1
PL_6_k:
  buffer_load_dwordx4 a[0:3], v1, s[8:11], s44 offen offset:0 sc1
  buffer_load_dwordx4 a[16:19], v1, s[8:11], s44 offen offset:1024 sc1
  buffer_load_dwordx4 a[32:35], v1, s[8:11], s44 offen offset:2048 sc1
  buffer_load_dwordx4 a[48:51], v1, s[8:11], s44 offen offset:3072 sc1
  buffer_load_dwordx4 a[64:67], v1, s[8:11], s48 offen offset:0 sc1
  buffer_load_dwordx4 a[4:7], v1, s[8:11], s45 offen offset:0 sc1
  buffer_load_dwordx4 a[20:23], v1, s[8:11], s45 offen offset:1024 sc1
  buffer_load_dwordx4 a[36:39], v1, s[8:11], s45 offen offset:2048 sc1
  buffer_load_dwordx4 a[52:55], v1, s[8:11], s45 offen offset:3072 sc1
  buffer_load_dwordx4 a[68:71], v1, s[8:11], s49 offen offset:0 sc1
  s_barrier
  s_waitcnt vmcnt(9)
  v_mfma_f32_16x16x32_bf16 v[16:19], a[160:163], a[0:3], 0
  buffer_load_dwordx4 a[8:11], v1, s[8:11], s46 offen offset:0 sc1
  v_mfma_f32_16x16x32_bf16 v[20:23], a[164:167], a[0:3], 0
  v_mfma_f32_16x16x32_bf16 v[24:27], a[168:171], a[0:3], 0
  v_mfma_f32_16x16x32_bf16 v[28:31], a[172:175], a[0:3], 0
  v_mfma_f32_16x16x32_bf16 v[32:35], a[176:179], a[0:3], 0
  s_waitcnt vmcnt(9)
  v_mfma_f32_16x16x32_bf16 v[16:19], a[180:183], a[16:19], v[16:19]
  buffer_load_dwordx4 a[24:27], v1, s[8:11], s46 offen offset:1024 sc1
  v_mfma_f32_16x16x32_bf16 v[20:23], a[184:187], a[16:19], v[20:23]
  v_mfma_f32_16x16x32_bf16 v[24:27], a[188:191], a[16:19], v[24:27]
  v_mfma_f32_16x16x32_bf16 v[28:31], a[192:195], a[16:19], v[28:31]
  v_mfma_f32_16x16x32_bf16 v[32:35], a[196:199], a[16:19], v[32:35]
  s_waitcnt vmcnt(9)
  v_mfma_f32_16x16x32_bf16 v[16:19], a[200:203], a[32:35], v[16:19]
  buffer_load_dwordx4 a[40:43], v1, s[8:11], s46 offen offset:2048 sc1
  v_mfma_f32_16x16x32_bf16 v[20:23], a[204:207], a[32:35], v[20:23]
  v_mfma_f32_16x16x32_bf16 v[24:27], a[208:211], a[32:35], v[24:27]
  v_mfma_f32_16x16x32_bf16 v[28:31], a[212:215], a[32:35], v[28:31]
  v_mfma_f32_16x16x32_bf16 v[32:35], a[216:219], a[32:35], v[32:35]
  s_waitcnt vmcnt(9)
  v_mfma_f32_16x16x32_bf16 v[16:19], a[220:223], a[48:51], v[16:19]
  buffer_load_dwordx4 a[56:59], v1, s[8:11], s46 offen offset:3072 sc1
  v_mfma_f32_16x16x32_bf16 v[20:23], a[224:227], a[48:51], v[20:23]
  v_mfma_f32_16x16x32_bf16 v[24:27], a[228:231], a[48:51], v[24:27]
  v_mfma_f32_16x16x32_bf16 v[28:31], a[232:235], a[48:51], v[28:31]
  v_mfma_f32_16x16x32_bf16 v[32:35], a[236:239], a[48:51], v[32:35]
  s_waitcnt vmcnt(9)
  v_mfma_f32_16x16x32_bf16 v[16:19], a[240:243], a[64:67], v[16:19]
  buffer_load_dwordx4 a[72:75], v1, s[8:11], s50 offen offset:0 sc1
  v_mfma_f32_16x16x32_bf16 v[20:23], a[244:247], a[64:67], v[20:23]
  v_mfma_f32_16x16x32_bf16 v[24:27], a[248:251], a[64:67], v[24:27]
  v_mfma_f32_16x16x32_bf16 v[28:31], a[252:255], a[64:67], v[28:31]
  v_mfma_f32_16x16x32_bf16 v[32:35], v[140:143], a[64:67], v[32:35]
  s_waitcnt vmcnt(9)
  v_mfma_f32_16x16x32_bf16 v[36:39], a[160:163], a[4:7], 0
  buffer_load_dwordx4 a[12:15], v1, s[8:11], s47 offen offset:0 sc1
  v_mfma_f32_16x16x32_bf16 v[40:43], a[164:167], a[4:7], 0
  v_mfma_f32_16x16x32_bf16 v[44:47], a[168:171], a[4:7], 0
  v_mfma_f32_16x16x32_bf16 v[48:51], a[172:175], a[4:7], 0
  s_add_u32 s31, s18, 1
  s_and_b32 s31, s31, 3
  v_mfma_f32_16x16x32_bf16 v[52:55], a[176:179], a[4:7], 0
  s_mul_i32 s31, s31, 15360
  s_add_u32 s31, s31, 0
  s_waitcnt vmcnt(9)
  v_mfma_f32_16x16x32_bf16 v[36:39], a[180:183], a[20:23], v[36:39]
  buffer_load_dwordx4 a[28:31], v1, s[8:11], s47 offen offset:1024 sc1
  v_add_u32 v226, s31, v1
  ds_write_b128 v226, v[16:19] offset:0
  v_mfma_f32_16x16x32_bf16 v[40:43], a[184:187], a[20:23], v[40:43]
  v_mfma_f32_16x16x32_bf16 v[44:47], a[188:191], a[20:23], v[44:47]
  ds_write_b128 v226, v[20:23] offset:1024
  v_mfma_f32_16x16x32_bf16 v[48:51], a[192:195], a[20:23], v[48:51]
  v_mfma_f32_16x16x32_bf16 v[52:55], a[196:199], a[20:23], v[52:55]
  ds_write_b128 v226, v[24:27] offset:2048
  s_waitcnt vmcnt(9)
  v_mfma_f32_16x16x32_bf16 v[36:39], a[200:203], a[36:39], v[36:39]
  buffer_load_dwordx4 a[44:47], v1, s[8:11], s47 offen offset:2048 sc1
  v_mfma_f32_16x16x32_bf16 v[40:43], a[204:207], a[36:39], v[40:43]
  ds_write_b128 v226, v[28:31] offset:3072
  v_mfma_f32_16x16x32_bf16 v[44:47], a[208:211], a[36:39], v[44:47]
  v_mfma_f32_16x16x32_bf16 v[48:51], a[212:215], a[36:39], v[48:51]
  ds_write_b128 v226, v[32:35] offset:4096
  v_mfma_f32_16x16x32_bf16 v[52:55], a[216:219], a[36:39], v[52:55]
  s_waitcnt vmcnt(9)
  v_mfma_f32_16x16x32_bf16 v[36:39], a[220:223], a[52:55], v[36:39]
  buffer_load_dwordx4 a[60:63], v1, s[8:11], s47 offen offset:3072 sc1
  v_mfma_f32_16x16x32_bf16 v[40:43], a[224:227], a[52:55], v[40:43]
  v_mfma_f32_16x16x32_bf16 v[44:47], a[228:231], a[52:55], v[44:47]
  v_mfma_f32_16x16x32_bf16 v[48:51], a[232:235], a[52:55], v[48:51]
  v_mfma_f32_16x16x32_bf16 v[52:55], a[236:239], a[52:55], v[52:55]
  s_waitcnt vmcnt(9)
  v_mfma_f32_16x16x32_bf16 v[36:39], a[240:243], a[68:71], v[36:39]
  buffer_load_dwordx4 a[76:79], v1, s[8:11], s51 offen offset:0 sc1
  v_mfma_f32_16x16x32_bf16 v[40:43], a[244:247], a[68:71], v[40:43]
  v_mfma_f32_16x16x32_bf16 v[44:47], a[248:251], a[68:71], v[44:47]
  v_mfma_f32_16x16x32_bf16 v[48:51], a[252:255], a[68:71], v[48:51]
  v_mfma_f32_16x16x32_bf16 v[52:55], v[140:143], a[68:71], v[52:55]
  s_waitcnt vmcnt(9)
  v_mfma_f32_16x16x32_bf16 v[56:59], a[160:163], a[8:11], 0
  s_add_u32 s27, s52, 20480
  buffer_load_dwordx4 v[192:195], v1, s[8:11], s27 offen offset:0 sc1
  v_mfma_f32_16x16x32_bf16 v[60:63], a[164:167], a[8:11], 0
  v_mfma_f32_16x16x32_bf16 v[64:67], a[168:171], a[8:11], 0
  v_mfma_f32_16x16x32_bf16 v[68:71], a[172:175], a[8:11], 0
  s_add_u32 s31, s18, 2
  s_and_b32 s31, s31, 3
  v_mfma_f32_16x16x32_bf16 v[72:75], a[176:179], a[8:11], 0
  s_mul_i32 s31, s31, 15360
  s_add_u32 s31, s31, 5120
  s_waitcnt vmcnt(9)
  v_mfma_f32_16x16x32_bf16 v[56:59], a[180:183], a[24:27], v[56:59]
  buffer_load_dwordx4 v[196:199], v1, s[8:11], s27 offen offset:1024 sc1
  v_add_u32 v226, s31, v1
  ds_write_b128 v226, v[36:39] offset:0
  v_mfma_f32_16x16x32_bf16 v[60:63], a[184:187], a[24:27], v[60:63]
  v_mfma_f32_16x16x32_bf16 v[64:67], a[188:191], a[24:27], v[64:67]
  ds_write_b128 v226, v[40:43] offset:1024
  v_mfma_f32_16x16x32_bf16 v[68:71], a[192:195], a[24:27], v[68:71]
  v_mfma_f32_16x16x32_bf16 v[72:75], a[196:199], a[24:27], v[72:75]
  ds_write_b128 v226, v[44:47] offset:2048
  s_waitcnt vmcnt(9)
  v_mfma_f32_16x16x32_bf16 v[56:59], a[200:203], a[40:43], v[56:59]
  buffer_load_dwordx4 v[200:203], v1, s[8:11], s27 offen offset:2048 sc1
  v_mfma_f32_16x16x32_bf16 v[60:63], a[204:207], a[40:43], v[60:63]
  ds_write_b128 v226, v[48:51] offset:3072
  v_mfma_f32_16x16x32_bf16 v[64:67], a[208:211], a[40:43], v[64:67]
  v_mfma_f32_16x16x32_bf16 v[68:71], a[212:215], a[40:43], v[68:71]
  ds_write_b128 v226, v[52:55] offset:4096
  v_mfma_f32_16x16x32_bf16 v[72:75], a[216:219], a[40:43], v[72:75]
  s_waitcnt vmcnt(9)
  v_mfma_f32_16x16x32_bf16 v[56:59], a[220:223], a[56:59], v[56:59]
  buffer_load_dwordx4 v[204:207], v1, s[8:11], s27 offen offset:3072 sc1
  v_mfma_f32_16x16x32_bf16 v[60:63], a[224:227], a[56:59], v[60:63]
  v_mfma_f32_16x16x32_bf16 v[64:67], a[228:231], a[56:59], v[64:67]
  v_mfma_f32_16x16x32_bf16 v[68:71], a[232:235], a[56:59], v[68:71]
  v_mfma_f32_16x16x32_bf16 v[72:75], a[236:239], a[56:59], v[72:75]
  s_waitcnt vmcnt(9)
  v_mfma_f32_16x16x32_bf16 v[56:59], a[240:243], a[72:75], v[56:59]
  s_add_u32 s27, s52, 24576
  buffer_load_dwordx4 v[208:211], v1, s[8:11], s27 offen offset:0 sc1
  v_mfma_f32_16x16x32_bf16 v[60:63], a[244:247], a[72:75], v[60:63]
  v_mfma_f32_16x16x32_bf16 v[64:67], a[248:251], a[72:75], v[64:67]
  v_mfma_f32_16x16x32_bf16 v[68:71], a[252:255], a[72:75], v[68:71]
  v_mfma_f32_16x16x32_bf16 v[72:75], v[140:143], a[72:75], v[72:75]
  s_waitcnt vmcnt(9)
  v_mfma_f32_16x16x32_bf16 v[76:79], a[160:163], a[12:15], 0
  v_mfma_f32_16x16x32_bf16 v[80:83], a[164:167], a[12:15], 0
  v_mfma_f32_16x16x32_bf16 v[84:87], a[168:171], a[12:15], 0
  v_mfma_f32_16x16x32_bf16 v[88:91], a[172:175], a[12:15], 0
  s_add_u32 s31, s18, 3
  s_and_b32 s31, s31, 3
  v_mfma_f32_16x16x32_bf16 v[92:95], a[176:179], a[12:15], 0
  s_mul_i32 s31, s31, 15360
  s_add_u32 s31, s31, 10240
  s_waitcnt vmcnt(8)
  v_mfma_f32_16x16x32_bf16 v[76:79], a[180:183], a[28:31], v[76:79]
  v_add_u32 v226, s31, v1
  ds_write_b128 v226, v[56:59] offset:0
  v_mfma_f32_16x16x32_bf16 v[80:83], a[184:187], a[28:31], v[80:83]
  v_mfma_f32_16x16x32_bf16 v[84:87], a[188:191], a[28:31], v[84:87]
  ds_write_b128 v226, v[60:63] offset:1024
  v_mfma_f32_16x16x32_bf16 v[88:91], a[192:195], a[28:31], v[88:91]
  v_mfma_f32_16x16x32_bf16 v[92:95], a[196:199], a[28:31], v[92:95]
  ds_write_b128 v226, v[64:67] offset:2048
  s_waitcnt vmcnt(7)
  v_mfma_f32_16x16x32_bf16 v[76:79], a[200:203], a[44:47], v[76:79]
  v_mfma_f32_16x16x32_bf16 v[80:83], a[204:207], a[44:47], v[80:83]
  ds_write_b128 v226, v[68:71] offset:3072
  v_mfma_f32_16x16x32_bf16 v[84:87], a[208:211], a[44:47], v[84:87]
  v_mfma_f32_16x16x32_bf16 v[88:91], a[212:215], a[44:47], v[88:91]
  ds_write_b128 v226, v[72:75] offset:4096
  v_mfma_f32_16x16x32_bf16 v[92:95], a[216:219], a[44:47], v[92:95]
  s_waitcnt vmcnt(6)
  v_mfma_f32_16x16x32_bf16 v[76:79], a[220:223], a[60:63], v[76:79]
  v_mfma_f32_16x16x32_bf16 v[80:83], a[224:227], a[60:63], v[80:83]
  v_mfma_f32_16x16x32_bf16 v[84:87], a[228:231], a[60:63], v[84:87]
  v_mfma_f32_16x16x32_bf16 v[88:91], a[232:235], a[60:63], v[88:91]
  v_mfma_f32_16x16x32_bf16 v[92:95], a[236:239], a[60:63], v[92:95]
  s_waitcnt vmcnt(5)
  v_mfma_f32_16x16x32_bf16 v[76:79], a[240:243], a[76:79], v[76:79]
  v_mfma_f32_16x16x32_bf16 v[80:83], a[244:247], a[76:79], v[80:83]
  v_mfma_f32_16x16x32_bf16 v[84:87], a[248:251], a[76:79], v[84:87]
  v_mfma_f32_16x16x32_bf16 v[88:91], a[252:255], a[76:79], v[88:91]
  v_mfma_f32_16x16x32_bf16 v[92:95], v[140:143], a[76:79], v[92:95]
  s_nop 3
  v_pk_add_f32 v[236:237], v[236:237], v[76:77]
  v_pk_add_f32 v[238:239], v[238:239], v[78:79]
  v_pk_add_f32 v[240:241], v[240:241], v[80:81]
  v_pk_add_f32 v[242:243], v[242:243], v[82:83]
  v_pk_add_f32 v[244:245], v[244:245], v[84:85]
  v_pk_add_f32 v[246:247], v[246:247], v[86:87]
  v_pk_add_f32 v[248:249], v[248:249], v[88:89]
  v_pk_add_f32 v[250:251], v[250:251], v[90:91]
  v_pk_add_f32 v[252:253], v[252:253], v[92:93]
  v_pk_add_f32 v[254:255], v[254:255], v[94:95]
  s_mul_i32 s33, s18, 15360
  s_add_u32 s33, s33, 0
  v_add_u32 v176, s33, v1
  s_add_u32 s27, s52, 0
  buffer_load_dwordx4 a[160:163], v1, s[8:11], s27 offen offset:0 sc1
  buffer_load_dwordx4 a[164:167], v1, s[8:11], s27 offen offset:1024 sc1
  s_waitcnt lgkmcnt(0)
  s_barrier
  ds_read_b128 v[96:99], v176 offset:0
  ds_read_b128 v[100:103], v176 offset:1024
  ds_read_b128 v[104:107], v176 offset:2048
  ds_read_b128 v[108:111], v176 offset:3072
  ds_read_b128 v[112:115], v176 offset:4096
  ds_read_b128 v[116:119], v176 offset:5120
  ds_read_b128 v[120:123], v176 offset:6144
  ds_read_b128 v[124:127], v176 offset:7168
  ds_read_b128 v[128:131], v176 offset:8192
  ds_read_b128 v[132:135], v176 offset:9216
  ds_read_b128 v[136:139], v176 offset:10240
  ds_read_b128 v[140:143], v176 offset:11264
  ds_read_b128 v[144:147], v176 offset:12288
  ds_read_b128 v[148:151], v176 offset:13312
  ds_read_b128 v[152:155], v176 offset:14336
  buffer_load_dwordx4 a[168:171], v1, s[8:11], s27 offen offset:2048 sc1
  buffer_load_dwordx4 a[172:175], v1, s[8:11], s27 offen offset:3072 sc1
  s_lshl_b32 s35, s19, 1
  s_add_u32 s35, s35, 1
  s_lshl_b32 s36, s16, 3
  s_lshl_b32 s37, s21, 2
  s_add_u32 s36, s36, s37
  s_add_u32 s36, s36, s18
  s_mul_i32 s33, s35, 2621440
  s_lshr_b32 s37, s36, 1
  s_mul_i32 s37, s37, 40960
  s_add_u32 s33, s33, s37
  s_and_b32 s37, s36, 1
  s_lshl_b32 s37, s37, 8
  s_add_u32 s33, s33, s37
  s_mul_i32 s37, s20, 5120
  s_add_u32 s33, s33, s37
  s_add_u32 s33, s33, 13357056
  s_add_u32 s34, s33, 4096
  s_mul_i32 s35, s35, 131072
  s_lshl_b32 s37, s20, 14
  s_add_u32 s35, s35, s37
  s_lshl_b32 s37, s36, 7
  s_add_u32 s35, s35, s37
  s_add_u32 s35, s35, 23842816
  s_add_u32 s27, s52, 4096
  buffer_load_dwordx4 a[176:179], v1, s[8:11], s27 offen offset:0 sc1
  s_waitcnt lgkmcnt(10)
  v_pk_add_f32 v[236:237], v[236:237], v[96:97]
  v_pk_add_f32 v[238:239], v[238:239], v[98:99]
  v_pk_add_f32 v[240:241], v[240:241], v[100:101]
  v_pk_add_f32 v[242:243], v[242:243], v[102:103]
  v_pk_add_f32 v[244:245], v[244:245], v[104:105]
  v_pk_add_f32 v[246:247], v[246:247], v[106:107]
  v_pk_add_f32 v[248:249], v[248:249], v[108:109]
  v_pk_add_f32 v[250:251], v[250:251], v[110:111]
  v_pk_add_f32 v[252:253], v[252:253], v[112:113]
  v_pk_add_f32 v[254:255], v[254:255], v[114:115]
  s_add_u32 s27, s52, 5120
  buffer_load_dwordx4 a[180:183], v1, s[8:11], s27 offen offset:0 sc1
  s_waitcnt lgkmcnt(5)
  v_pk_add_f32 v[236:237], v[236:237], v[116:117]
  v_pk_add_f32 v[238:239], v[238:239], v[118:119]
  v_pk_add_f32 v[240:241], v[240:241], v[120:121]
  v_pk_add_f32 v[242:243], v[242:243], v[122:123]
  v_pk_add_f32 v[244:245], v[244:245], v[124:125]
  v_pk_add_f32 v[246:247], v[246:247], v[126:127]
  v_pk_add_f32 v[248:249], v[248:249], v[128:129]
  v_pk_add_f32 v[250:251], v[250:251], v[130:131]
  v_pk_add_f32 v[252:253], v[252:253], v[132:133]
  v_pk_add_f32 v[254:255], v[254:255], v[134:135]
  buffer_load_dwordx4 a[184:187], v1, s[8:11], s27 offen offset:1024 sc1
  s_waitcnt lgkmcnt(0)
  v_pk_add_f32 v[236:237], v[236:237], v[136:137]
  v_pk_add_f32 v[238:239], v[238:239], v[138:139]
  v_pk_add_f32 v[240:241], v[240:241], v[140:141]
  v_pk_add_f32 v[242:243], v[242:243], v[142:143]
  v_pk_add_f32 v[244:245], v[244:245], v[144:145]
  v_pk_add_f32 v[246:247], v[246:247], v[146:147]
  v_pk_add_f32 v[248:249], v[248:249], v[148:149]
  v_pk_add_f32 v[250:251], v[250:251], v[150:151]
  v_pk_add_f32 v[252:253], v[252:253], v[152:153]
  v_pk_add_f32 v[254:255], v[254:255], v[154:155]
  v_cvt_pk_bf16_f32 v160, v236, v237
  v_cvt_pk_bf16_f32 v161, v238, v239
  v_cvt_pk_bf16_f32 v162, v240, v241
  v_cvt_pk_bf16_f32 v163, v242, v243
  v_cvt_pk_bf16_f32 v164, v244, v245
  v_cvt_pk_bf16_f32 v165, v246, v247
  v_cvt_pk_bf16_f32 v166, v248, v249
  v_cvt_pk_bf16_f32 v167, v250, v251
  v_cvt_pk_bf16_f32 v168, v252, v253
  v_cvt_pk_bf16_f32 v169, v254, v255
  buffer_store_dwordx4 v[160:163], v10, s[8:11], s33 offen sc1
  buffer_store_dwordx4 v[164:167], v10, s[8:11], s33 offen offset:2048 sc1
  buffer_store_dwordx2 v[168:169], v11, s[8:11], s34 offen sc1
  v_pk_mul_f32 v[174:175], v[236:237], v[236:237]
  v_pk_add_f32 v[172:173], v[236:237], v[238:239]
  v_pk_fma_f32 v[174:175], v[238:239], v[238:239], v[174:175]
  v_pk_fma_f32 v[174:175], v[240:241], v[240:241], v[174:175]
  v_pk_add_f32 v[172:173], v[172:173], v[240:241]
  v_pk_fma_f32 v[174:175], v[242:243], v[242:243], v[174:175]
  v_pk_add_f32 v[172:173], v[172:173], v[242:243]
  v_pk_fma_f32 v[174:175], v[244:245], v[244:245], v[174:175]
  v_pk_add_f32 v[172:173], v[172:173], v[244:245]
  v_pk_fma_f32 v[174:175], v[246:247], v[246:247], v[174:175]
  v_pk_add_f32 v[172:173], v[172:173], v[246:247]
  v_pk_fma_f32 v[174:175], v[248:249], v[248:249], v[174:175]
  v_pk_add_f32 v[172:173], v[172:173], v[248:249]
  v_pk_fma_f32 v[174:175], v[250:251], v[250:251], v[174:175]
  v_pk_add_f32 v[172:173], v[172:173], v[250:251]
  v_pk_fma_f32 v[174:175], v[252:253], v[252:253], v[174:175]
  v_pk_add_f32 v[172:173], v[172:173], v[252:253]
  v_pk_fma_f32 v[174:175], v[254:255], v[254:255], v[174:175]
  v_pk_add_f32 v[172:173], v[172:173], v[254:255]
  v_add_f32 v172, v172, v173
  v_add_f32 v173, v174, v175
  v_mov_b32 v174, v172
  v_mov_b32 v175, v173
  s_nop 0
  v_permlane32_swap_b32 v172, v174
  v_permlane32_swap_b32 v173, v175
  v_pk_add_f32 v[172:173], v[172:173], v[174:175]
  v_mov_b32 v174, v172
  v_mov_b32 v175, v173
  s_nop 0
  v_permlane16_swap_b32 v172, v174
  v_permlane16_swap_b32 v173, v175
  v_pk_add_f32 v[172:173], v[172:173], v[174:175]
  v_lshrrev_b32 v174, 1, v1
  s_mov_b64 exec, 0xffff
  buffer_store_dwordx2 v[172:173], v174, s[8:11], s35 offen sc1
  s_mov_b64 exec, -1
  s_mul_i32 s30, s19, 917504
  s_lshl_b32 s31, s16, 13
  s_add_u32 s30, s30, s31
  s_add_u32 s30, s30, 131072
  s_add_u32 s30, s30, s22
  v_mov_b32 v14, s25
  s_waitcnt vmcnt(0)
  s_mov_b64 exec, 1
  buffer_store_dword v14, v4, s[8:11], s30 offen sc1
  s_mov_b64 exec, -1
  s_barrier
  s_add_u32 s28, s40, 81920
  s_add_u32 m0, s41, 0
  s_nop 0
  buffer_load_dwordx4 v1, s[8:11], s28 offen offset:0 sc1 lds
  buffer_load_dwordx4 v1, s[8:11], s28 offen offset:1024 sc1 lds
  buffer_load_dwordx4 v1, s[8:11], s28 offen offset:2048 sc1 lds
  buffer_load_dwordx4 v1, s[8:11], s28 offen offset:3072 sc1 lds
  s_add_u32 s28, s40, 86016
  s_add_u32 m0, s41, 4096
  s_nop 0
  buffer_load_dwordx4 v1, s[8:11], s28 offen offset:0 sc1 lds
  s_add_u32 s28, s40, 102400
  s_add_u32 m0, s41, 20480
  s_nop 0
  buffer_load_dwordx4 v1, s[8:11], s28 offen offset:0 sc1 lds
  buffer_load_dwordx4 v1, s[8:11], s28 offen offset:1024 sc1 lds
  buffer_load_dwordx4 v1, s[8:11], s28 offen offset:2048 sc1 lds
  buffer_load_dwordx4 v1, s[8:11], s28 offen offset:3072 sc1 lds
  s_add_u32 s28, s40, 106496
  s_add_u32 m0, s41, 24576
  s_nop 0
  buffer_load_dwordx4 v1, s[8:11], s28 offen offset:0 sc1 lds
  s_mul_i32 s42, s19, 7077888
  s_lshl_b32 s35, s16, 3
  s_lshl_b32 s33, s18, 1
  s_add_u32 s35, s35, s33
  s_mul_i32 s35, s35, 55296
  s_add_u32 s42, s42, s35
  s_lshr_b32 s35, s17, 2
  s_mul_i32 s35, s35, 14336
  s_add_u32 s42, s42, s35
  s_add_u32 s42, s42, 41144320
  s_and_b32 s33, s17, 3
  s_cmp_ge_u32 s17, 12
  s_mov_b32 s35, 1536
  s_cselect_b32 s35, 1024, s35
  s_mul_i32 s35, s35, s33
  s_add_u32 s51, s42, s35
  s_add_u32 s51, s51, 8192
  s_lshl_b32 s33, s33, 11
  s_add_u32 s42, s42, s33
  s_mul_i32 s33, s19, 7077888
  s_lshl_b32 s35, s16, 3
  s_lshl_b32 s34, s21, 2
  s_add_u32 s35, s35, s34
  s_mul_i32 s35, s35, 55296
  s_add_u32 s33, s33, s35
  s_lshl_b32 s35, s43, 10
  s_add_u32 s33, s33, s35
  s_add_u32 s31, s18, 1
  s_and_b32 s31, s31, 3
  s_mul_i32 s31, s31, 55296
  s_add_u32 s31, s31, s33
  s_add_u32 s44, s31, 41144320
  s_add_u32 s31, s18, 2
  s_and_b32 s31, s31, 3
  s_mul_i32 s31, s31, 55296
  s_add_u32 s31, s31, s33
  s_add_u32 s45, s31, 41144320
  s_add_u32 s31, s18, 3
  s_and_b32 s31, s31, 3
  s_mul_i32 s31, s31, 55296
  s_add_u32 s31, s31, s33
  s_add_u32 s46, s31, 41144320
  s_add_u32 s31, s18, 4
  s_and_b32 s31, s31, 3
  s_mul_i32 s31, s31, 55296
  s_add_u32 s31, s31, s33
  s_add_u32 s47, s31, 41144320
  s_lshl_b32 s35, s19, 1
  s_add_u32 s35, s35, 1
  s_mul_i32 s33, s35, 2621440
  s_lshl_b32 s34, s16, 2
  s_add_u32 s34, s34, s18
  s_mul_i32 s36, s34, 40960
  s_add_u32 s38, s33, s36
  s_mul_i32 s35, s35, 131072
  s_lshl_b32 s34, s34, 8
  s_add_u32 s39, s35, s34
  s_add_u32 s37, s88, 1024
  s_mul_i32 s24, s19, 917504
  s_lshl_b32 s31, s16, 13
  s_add_u32 s24, s24, s31
  s_add_u32 s24, s24, 131072
  s_lshr_b32 s31, s18, 1
  s_lshl_b32 s31, s31, 11
  s_add_u32 s24, s24, s31
  s_and_b32 s31, s18, 1
  s_lshl_b32 s31, s31, 8
  s_add_u32 s24, s24, s31
  v_and_b32 v225, 4, v5
  v_lshlrev_b32 v225, 10, v225
  v_and_b32 v224, 3, v5
  v_lshl_add_u32 v225, v224, 9, v225
  v_bfe_u32 v224, v5, 3, 1
  v_lshl_add_u32 v225, v224, 7, v225
  v_mov_b32 v224, s25
  s_mov_b64 exec, 0xffff
  buffer_load_dword v224, v225, s[8:11], s24 offen sc1
  s_mov_b64 exec, -1
  s_waitcnt vmcnt(0)
  v_cmp_ne_u32 vcc, s25, v224
  s_cbranch_vccz PL_7_k
  s_mov_b32 s32, 0x40000
  s_mov_b64 exec, 0xffff
PL_7_p:
  buffer_load_dword v224, v225, s[8:11], s24 offen sc1
  s_sub_u32 s32, s32, 1
  s_cbranch_scc1 PL_7_d
  s_waitcnt vmcnt(0)
  v_cmp_ne_u32 vcc, s25, v224
  s_cbranch_vccnz PL_7_p
PL_7_d:
  s_mov_b64 exec, -1
PL_7_k:
  s_add_u32 s29, s38, 13357056
  buffer_load_dwordx4 a[0:3], v1, s[8:11], s29 offen offset:0 sc1
  buffer_load_dwordx4 a[4:7], v1, s[8:11], s29 offen offset:1024 sc1
  buffer_load_dwordx4 a[8:11], v1, s[8:11], s29 offen offset:2048 sc1
  buffer_load_dwordx4 a[12:15], v1, s[8:11], s29 offen offset:3072 sc1
  s_add_u32 s29, s38, 13361152
  buffer_load_dwordx4 a[16:19], v1, s[8:11], s29 offen offset:0 sc1
  buffer_load_dwordx4 a[20:23], v1, s[8:11], s29 offen offset:1024 sc1
  buffer_load_dwordx4 a[24:27], v1, s[8:11], s29 offen offset:2048 sc1
  buffer_load_dwordx4 a[28:31], v1, s[8:11], s29 offen offset:3072 sc1
  s_add_u32 s29, s38, 13365248
  buffer_load_dwordx4 a[32:35], v1, s[8:11], s29 offen offset:0 sc1
  buffer_load_dwordx4 a[36:39], v1, s[8:11], s29 offen offset:1024 sc1
  s_barrier
  ds_read_b128 v[128:131], v2 offset:16384
  ds_read_b128 v[132:135], v2 offset:17408
  ds_read_b128 v[136:139], v2 offset:18432
  ds_read_b128 v[140:143], v2 offset:19456
  ds_read_b128 v[144:147], v2 offset:20480
  ds_read_b128 v[148:151], v2 offset:21504
  s_waitcnt vmcnt(9)
  s_waitcnt lgkmcnt(4)
  v_mfma_f32_32x32x16_bf16 v[16:31], v[128:131], a[0:3], 0
  ds_read_b128 v[152:155], v2 offset:22528
  buffer_load_dwordx4 a[40:43], v1, s[8:11], s29 offen offset:2048 sc1
  v_mfma_f32_32x32x16_bf16 v[32:47], v[132:135], a[0:3], 0
  ds_read_b128 v[156:159], v2 offset:23552
  s_waitcnt lgkmcnt(4)
  v_mfma_f32_32x32x16_bf16 v[48:63], v[136:139], a[0:3], 0
  ds_read_b128 v[128:131], v2 offset:24576
  s_add_u32 s28, s40, 122880
  s_add_u32 m0, s41, 40960
  s_nop 0
  buffer_load_dwordx4 v1, s[8:11], s28 offen offset:0 sc1 lds
  v_mfma_f32_32x32x16_bf16 v[64:79], v[140:143], a[0:3], 0
  ds_read_b128 v[132:135], v2 offset:25600
  s_waitcnt vmcnt(10)
  s_waitcnt lgkmcnt(4)
  v_mfma_f32_32x32x16_bf16 v[16:31], v[144:147], a[4:7], v[16:31]
  ds_read_b128 v[136:139], v2 offset:26624
  buffer_load_dwordx4 a[44:47], v1, s[8:11], s29 offen offset:3072 sc1
  v_mfma_f32_32x32x16_bf16 v[32:47], v[148:151], a[4:7], v[32:47]
  ds_read_b128 v[140:143], v2 offset:27648
  s_waitcnt lgkmcnt(4)
  v_mfma_f32_32x32x16_bf16 v[48:63], v[152:155], a[4:7], v[48:63]
  ds_read_b128 v[144:147], v2 offset:28672
  buffer_load_dwordx4 v1, s[8:11], s28 offen offset:1024 sc1 lds
  v_mfma_f32_32x32x16_bf16 v[64:79], v[156:159], a[4:7], v[64:79]
  ds_read_b128 v[148:151], v2 offset:29696
  s_waitcnt vmcnt(11)
  s_waitcnt lgkmcnt(4)
  v_mfma_f32_32x32x16_bf16 v[16:31], v[128:131], a[8:11], v[16:31]
  ds_read_b128 v[152:155], v2 offset:30720
  s_add_u32 s29, s38, 13369344
  buffer_load_dwordx4 a[48:51], v1, s[8:11], s29 offen offset:0 sc1
  v_mfma_f32_32x32x16_bf16 v[32:47], v[132:135], a[8:11], v[32:47]
  ds_read_b128 v[156:159], v2 offset:31744
  s_waitcnt lgkmcnt(4)
  v_mfma_f32_32x32x16_bf16 v[48:63], v[136:139], a[8:11], v[48:63]
  ds_read_b128 v[128:131], v2 offset:32768
  buffer_load_dwordx4 v1, s[8:11], s28 offen offset:2048 sc1 lds
  v_mfma_f32_32x32x16_bf16 v[64:79], v[140:143], a[8:11], v[64:79]
  ds_read_b128 v[132:135], v2 offset:33792
  s_waitcnt vmcnt(12)
  s_waitcnt lgkmcnt(4)
  v_mfma_f32_32x32x16_bf16 v[16:31], v[144:147], a[12:15], v[16:31]
  ds_read_b128 v[136:139], v2 offset:34816
  buffer_load_dwordx4 a[52:55], v1, s[8:11], s29 offen offset:1024 sc1
  v_mfma_f32_32x32x16_bf16 v[32:47], v[148:151], a[12:15], v[32:47]
  ds_read_b128 v[140:143], v2 offset:35840
  s_waitcnt lgkmcnt(4)
  v_mfma_f32_32x32x16_bf16 v[48:63], v[152:155], a[12:15], v[48:63]
  ds_read_b128 v[144:147], v2 offset:36864
  buffer_load_dwordx4 v1, s[8:11], s28 offen offset:3072 sc1 lds
  v_mfma_f32_32x32x16_bf16 v[64:79], v[156:159], a[12:15], v[64:79]
  ds_read_b128 v[148:151], v2 offset:37888
  s_waitcnt vmcnt(13)
  s_waitcnt lgkmcnt(4)
  v_mfma_f32_32x32x16_bf16 v[16:31], v[128:131], a[16:19], v[16:31]
  ds_read_b128 v[152:155], v2 offset:38912
  buffer_load_dwordx4 a[56:59], v1, s[8:11], s29 offen offset:2048 sc1
  v_mfma_f32_32x32x16_bf16 v[32:47], v[132:135], a[16:19], v[32:47]
  ds_read_b128 v[156:159], v2 offset:39936
  s_waitcnt lgkmcnt(4)
  v_mfma_f32_32x32x16_bf16 v[48:63], v[136:139], a[16:19], v[48:63]
  ds_read_b128 v[128:131], v2 offset:40960
  s_add_u32 s28, s40, 126976
  s_add_u32 m0, s41, 45056
  s_nop 0
  buffer_load_dwordx4 v1, s[8:11], s28 offen offset:0 sc1 lds
  v_mfma_f32_32x32x16_bf16 v[64:79], v[140:143], a[16:19], v[64:79]
  ds_read_b128 v[132:135], v2 offset:41984
  s_waitcnt vmcnt(14)
  s_waitcnt lgkmcnt(4)
  v_mfma_f32_32x32x16_bf16 v[16:31], v[144:147], a[20:23], v[16:31]
  ds_read_b128 v[136:139], v2 offset:43008
  buffer_load_dwordx4 a[60:63], v1, s[8:11], s29 offen offset:3072 sc1
  v_mfma_f32_32x32x16_bf16 v[32:47], v[148:151], a[20:23], v[32:47]
  ds_read_b128 v[140:143], v2 offset:44032
  s_add_u32 s31, s39, 23842816
  buffer_load_dwordx2 v[224:225], v7, s[8:11], s31 offen sc1
  s_waitcnt lgkmcnt(4)
  v_mfma_f32_32x32x16_bf16 v[48:63], v[152:155], a[20:23], v[48:63]
  ds_read_b128 v[144:147], v2 offset:45056
  s_add_u32 s28, s40, 143360
  s_add_u32 m0, s41, 61440
  s_nop 0
  buffer_load_dwordx4 v1, s[8:11], s28 offen offset:0 sc1 lds
  v_mfma_f32_32x32x16_bf16 v[64:79], v[156:159], a[20:23], v[64:79]
  ds_read_b128 v[148:151], v2 offset:46080
  s_add_u32 s31, s39, 23859200
  buffer_load_dwordx2 v[226:227], v7, s[8:11], s31 offen sc1
  s_waitcnt vmcnt(17)
  s_waitcnt lgkmcnt(4)
  v_mfma_f32_32x32x16_bf16 v[16:31], v[128:131], a[24:27], v[16:31]
  ds_read_b128 v[152:155], v2 offset:47104
  s_add_u32 s31, s39, 23875584
  buffer_load_dwordx2 v[228:229], v7, s[8:11], s31 offen sc1
  v_mfma_f32_32x32x16_bf16 v[32:47], v[132:135], a[24:27], v[32:47]
  ds_read_b128 v[156:159], v2 offset:48128
  s_add_u32 s31, s39, 23891968
  buffer_load_dwordx2 v[230:231], v7, s[8:11], s31 offen sc1
  s_waitcnt lgkmcnt(4)
  v_mfma_f32_32x32x16_bf16 v[48:63], v[136:139], a[24:27], v[48:63]
  ds_read_b128 v[128:131], v2 offset:49152
  buffer_load_dwordx4 v1, s[8:11], s28 offen offset:1024 sc1 lds
  v_mfma_f32_32x32x16_bf16 v[64:79], v[140:143], a[24:27], v[64:79]
  ds_read_b128 v[132:135], v2 offset:50176
  v_lshlrev_b32 v15, 24, v6
  v_lshl_add_u32 v15, v5, 3, v15
  buffer_load_dwordx2 v[176:177], v15, s[8:11], s37 offen offset:0 sc1
  s_waitcnt vmcnt(20)
  s_waitcnt lgkmcnt(4)
  v_mfma_f32_32x32x16_bf16 v[16:31], v[144:147], a[28:31], v[16:31]
  ds_read_b128 v[136:139], v2 offset:51200
  buffer_load_dwordx2 v[178:179], v15, s[8:11], s37 offen offset:256 sc1
  v_mfma_f32_32x32x16_bf16 v[32:47], v[148:151], a[28:31], v[32:47]
  ds_read_b128 v[140:143], v2 offset:52224
  buffer_load_dwordx2 v[180:181], v15, s[8:11], s37 offen offset:512 sc1
  s_waitcnt lgkmcnt(4)
  v_mfma_f32_32x32x16_bf16 v[48:63], v[152:155], a[28:31], v[48:63]
  ds_read_b128 v[144:147], v2 offset:53248
  buffer_load_dwordx4 v1, s[8:11], s28 offen offset:2048 sc1 lds
  v_mfma_f32_32x32x16_bf16 v[64:79], v[156:159], a[28:31], v[64:79]
  ds_read_b128 v[148:151], v2 offset:54272
  buffer_load_dwordx2 v[182:183], v15, s[8:11], s37 offen offset:768 sc1
  s_waitcnt vmcnt(23)
  s_waitcnt lgkmcnt(4)
  v_mfma_f32_32x32x16_bf16 v[16:31], v[128:131], a[32:35], v[16:31]
  ds_read_b128 v[152:155], v2 offset:55296
  buffer_load_dwordx2 v[184:185], v15, s[8:11], s37 offen offset:1024 sc1
  v_mfma_f32_32x32x16_bf16 v[32:47], v[132:135], a[32:35], v[32:47]
  ds_read_b128 v[156:159], v2 offset:56320
  buffer_load_dwordx2 v[186:187], v15, s[8:11], s37 offen offset:1280 sc1
  s_waitcnt lgkmcnt(4)
  v_mfma_f32_32x32x16_bf16 v[48:63], v[136:139], a[32:35], v[48:63]
  s_barrier
  ds_read_b128 v[128:131], v2 offset:57344
  buffer_load_dwordx4 v1, s[8:11], s28 offen offset:3072 sc1 lds
  v_mfma_f32_32x32x16_bf16 v[64:79], v[140:143], a[32:35], v[64:79]
  ds_read_b128 v[132:135], v2 offset:58368
  buffer_load_dwordx2 v[188:189], v15, s[8:11], s37 offen offset:1536 sc1
  s_waitcnt vmcnt(26)
  s_waitcnt lgkmcnt(4)
  v_mfma_f32_32x32x16_bf16 v[16:31], v[144:147], a[36:39], v[16:31]
  ds_read_b128 v[136:139], v2 offset:59392
  s_add_u32 s29, s38, 13373440
  buffer_load_dwordx4 a[64:67], v1, s[8:11], s29 offen offset:0 sc1
  v_mfma_f32_32x32x16_bf16 v[32:47], v[148:151], a[36:39], v[32:47]
  ds_read_b128 v[140:143], v2 offset:60416
  s_waitcnt lgkmcnt(4)
  v_mfma_f32_32x32x16_bf16 v[48:63], v[152:155], a[36:39], v[48:63]
  ds_read_b128 v[144:147], v2 offset:61440
  s_add_u32 s28, s40, 147456
  s_add_u32 m0, s41, 65536
  s_nop 0
  buffer_load_dwordx4 v1, s[8:11], s28 offen offset:0 sc1 lds
  v_mfma_f32_32x32x16_bf16 v[64:79], v[156:159], a[36:39], v[64:79]
  ds_read_b128 v[148:151], v2 offset:62464
  s_waitcnt vmcnt(27)
  s_waitcnt lgkmcnt(4)
  v_mfma_f32_32x32x16_bf16 v[16:31], v[128:131], a[40:43], v[16:31]
  ds_read_b128 v[152:155], v2 offset:63488
  buffer_load_dwordx4 a[68:71], v1, s[8:11], s29 offen offset:1024 sc1
  v_mfma_f32_32x32x16_bf16 v[32:47], v[132:135], a[40:43], v[32:47]
  ds_read_b128 v[156:159], v2 offset:64512
  s_waitcnt lgkmcnt(4)
  v_mfma_f32_32x32x16_bf16 v[48:63], v[136:139], a[40:43], v[48:63]
  ds_read_b128 v[128:131], v3 offset:0
  s_add_u32 s28, s40, 163840
  s_add_u32 m0, s41, 81920
  s_nop 0
  buffer_load_dwordx4 v1, s[8:11], s28 offen offset:0 sc1 lds
  v_mfma_f32_32x32x16_bf16 v[64:79], v[140:143], a[40:43], v[64:79]
  ds_read_b128 v[132:135], v3 offset:1024
  s_waitcnt vmcnt(27)
  s_waitcnt lgkmcnt(4)
  v_mfma_f32_32x32x16_bf16 v[16:31], v[144:147], a[44:47], v[16:31]
  ds_read_b128 v[136:139], v3 offset:2048
  buffer_load_dwordx4 a[72:75], v1, s[8:11], s29 offen offset:2048 sc1
  v_mfma_f32_32x32x16_bf16 v[32:47], v[148:151], a[44:47], v[32:47]
  ds_read_b128 v[140:143], v3 offset:3072
  s_waitcnt lgkmcnt(4)
  v_mfma_f32_32x32x16_bf16 v[48:63], v[152:155], a[44:47], v[48:63]
  ds_read_b128 v[144:147], v3 offset:4096
  buffer_load_dwordx4 v1, s[8:11], s28 offen offset:1024 sc1 lds
  v_mfma_f32_32x32x16_bf16 v[64:79], v[156:159], a[44:47], v[64:79]
  ds_read_b128 v[148:151], v3 offset:5120
  s_waitcnt vmcnt(27)
  s_waitcnt lgkmcnt(4)
  v_mfma_f32_32x32x16_bf16 v[16:31], v[128:131], a[48:51], v[16:31]
  ds_read_b128 v[152:155], v3 offset:6144
  buffer_load_dwordx4 a[76:79], v1, s[8:11], s29 offen offset:3072 sc1
  v_mfma_f32_32x32x16_bf16 v[32:47], v[132:135], a[48:51], v[32:47]
  ds_read_b128 v[156:159], v3 offset:7168
  s_waitcnt lgkmcnt(4)
  v_mfma_f32_32x32x16_bf16 v[48:63], v[136:139], a[48:51], v[48:63]
  ds_read_b128 v[128:131], v3 offset:8192
  buffer_load_dwordx4 v1, s[8:11], s28 offen offset:2048 sc1 lds
  v_mfma_f32_32x32x16_bf16 v[64:79], v[140:143], a[48:51], v[64:79]
  ds_read_b128 v[132:135], v3 offset:9216
  s_waitcnt vmcnt(27)
  s_waitcnt lgkmcnt(4)
  v_mfma_f32_32x32x16_bf16 v[16:31], v[144:147], a[52:55], v[16:31]
  ds_read_b128 v[136:139], v3 offset:10240
  s_add_u32 s29, s38, 13377536
  buffer_load_dwordx4 a[80:83], v1, s[8:11], s29 offen offset:0 sc1
  v_mfma_f32_32x32x16_bf16 v[32:47], v[148:151], a[52:55], v[32:47]
  ds_read_b128 v[140:143], v3 offset:11264
  s_waitcnt lgkmcnt(4)
  v_mfma_f32_32x32x16_bf16 v[48:63], v[152:155], a[52:55], v[48:63]
  s_barrier
  ds_read_b128 v[144:147], v3 offset:12288
  buffer_load_dwordx4 v1, s[8:11], s28 offen offset:3072 sc1 lds
  v_mfma_f32_32x32x16_bf16 v[64:79], v[156:159], a[52:55], v[64:79]
  ds_read_b128 v[148:151], v3 offset:13312
  s_waitcnt vmcnt(27)
  s_waitcnt lgkmcnt(4)
  v_mfma_f32_32x32x16_bf16 v[16:31], v[128:131], a[56:59], v[16:31]
  ds_read_b128 v[152:155], v3 offset:14336
  buffer_load_dwordx4 a[84:87], v1, s[8:11], s29 offen offset:1024 sc1
  v_mfma_f32_32x32x16_bf16 v[32:47], v[132:135], a[56:59], v[32:47]
  ds_read_b128 v[156:159], v3 offset:15360
  s_waitcnt lgkmcnt(4)
  v_mfma_f32_32x32x16_bf16 v[48:63], v[136:139], a[56:59], v[48:63]
  ds_read_b128 v[128:131], v3 offset:16384
  s_add_u32 s28, s40, 167936
  s_add_u32 m0, s41, 86016
  s_nop 0
  buffer_load_dwordx4 v1, s[8:11], s28 offen offset:0 sc1 lds
  v_mfma_f32_32x32x16_bf16 v[64:79], v[140:143], a[56:59], v[64:79]
  ds_read_b128 v[132:135], v3 offset:17408
  s_waitcnt vmcnt(27)
  s_waitcnt lgkmcnt(4)
  v_mfma_f32_32x32x16_bf16 v[16:31], v[144:147], a[60:63], v[16:31]
  ds_read_b128 v[136:139], v3 offset:18432
  buffer_load_dwordx4 a[88:91], v1, s[8:11], s29 offen offset:2048 sc1
  v_mfma_f32_32x32x16_bf16 v[32:47], v[148:151], a[60:63], v[32:47]
  ds_read_b128 v[140:143], v3 offset:19456
  s_waitcnt lgkmcnt(4)
  v_mfma_f32_32x32x16_bf16 v[48:63], v[152:155], a[60:63], v[48:63]
  ds_read_b128 v[144:147], v3 offset:20480
  s_add_u32 s28, s40, 184320
  s_add_u32 m0, s41, 102400
  s_nop 0
  buffer_load_dwordx4 v1, s[8:11], s28 offen offset:0 sc1 lds
  v_mfma_f32_32x32x16_bf16 v[64:79], v[156:159], a[60:63], v[64:79]
  ds_read_b128 v[148:151], v3 offset:21504
  s_waitcnt vmcnt(13)
  s_waitcnt lgkmcnt(4)
  v_mfma_f32_32x32x16_bf16 v[16:31], v[128:131], a[64:67], v[16:31]
  ds_read_b128 v[152:155], v3 offset:22528
  buffer_load_dwordx4 a[92:95], v1, s[8:11], s29 offen offset:3072 sc1
  v_mfma_f32_32x32x16_bf16 v[32:47], v[132:135], a[64:67], v[32:47]
  ds_read_b128 v[156:159], v3 offset:23552
  s_waitcnt lgkmcnt(4)
  v_mfma_f32_32x32x16_bf16 v[48:63], v[136:139], a[64:67], v[48:63]
  ds_read_b128 v[128:131], v3 offset:24576
  buffer_load_dwordx4 v1, s[8:11], s28 offen offset:1024 sc1 lds
  v_mfma_f32_32x32x16_bf16 v[64:79], v[140:143], a[64:67], v[64:79]
  ds_read_b128 v[132:135], v3 offset:25600
  s_waitcnt vmcnt(13)
  s_waitcnt lgkmcnt(4)
  v_mfma_f32_32x32x16_bf16 v[16:31], v[144:147], a[68:71], v[16:31]
  ds_read_b128 v[136:139], v3 offset:26624
  s_add_u32 s29, s38, 13381632
  buffer_load_dwordx4 a[96:99], v1, s[8:11], s29 offen offset:0 sc1
  v_mfma_f32_32x32x16_bf16 v[32:47], v[148:151], a[68:71], v[32:47]
  ds_read_b128 v[140:143], v3 offset:27648
  s_waitcnt lgkmcnt(4)
  v_mfma_f32_32x32x16_bf16 v[48:63], v[152:155], a[68:71], v[48:63]
  ds_read_b128 v[144:147], v3 offset:28672
  buffer_load_dwordx4 v1, s[8:11], s28 offen offset:2048 sc1 lds
  v_mfma_f32_32x32x16_bf16 v[64:79], v[156:159], a[68:71], v[64:79]
  ds_read_b128 v[148:151], v3 offset:29696
  s_waitcnt vmcnt(13)
  s_waitcnt lgkmcnt(4)
  v_mfma_f32_32x32x16_bf16 v[16:31], v[128:131], a[72:75], v[16:31]
  ds_read_b128 v[152:155], v3 offset:30720
  buffer_load_dwordx4 a[100:103], v1, s[8:11], s29 offen offset:1024 sc1
  v_mfma_f32_32x32x16_bf16 v[32:47], v[132:135], a[72:75], v[32:47]
  ds_read_b128 v[156:159], v3 offset:31744
  s_waitcnt lgkmcnt(4)
  v_mfma_f32_32x32x16_bf16 v[48:63], v[136:139], a[72:75], v[48:63]
  s_barrier
  ds_read_b128 v[128:131], v1 offset:0
  buffer_load_dwordx4 v1, s[8:11], s28 offen offset:3072 sc1 lds
  v_mfma_f32_32x32x16_bf16 v[64:79], v[140:143], a[72:75], v[64:79]
  ds_read_b128 v[132:135], v1 offset:1024
  s_waitcnt vmcnt(13)
  s_waitcnt lgkmcnt(4)
  v_mfma_f32_32x32x16_bf16 v[16:31], v[144:147], a[76:79], v[16:31]
  ds_read_b128 v[136:139], v1 offset:2048
  buffer_load_dwordx4 a[104:107], v1, s[8:11], s29 offen offset:2048 sc1
  v_mfma_f32_32x32x16_bf16 v[32:47], v[148:151], a[76:79], v[32:47]
  ds_read_b128 v[140:143], v1 offset:3072
  s_waitcnt lgkmcnt(4)
  v_mfma_f32_32x32x16_bf16 v[48:63], v[152:155], a[76:79], v[48:63]
  ds_read_b128 v[144:147], v1 offset:4096
  s_add_u32 s28, s40, 188416
  s_add_u32 m0, s41, 106496
  s_nop 0
  buffer_load_dwordx4 v1, s[8:11], s28 offen offset:0 sc1 lds
  v_mfma_f32_32x32x16_bf16 v[64:79], v[156:159], a[76:79], v[64:79]
  ds_read_b128 v[148:151], v1 offset:5120
  s_waitcnt vmcnt(13)
  s_waitcnt lgkmcnt(4)
  v_mfma_f32_32x32x16_bf16 v[16:31], v[128:131], a[80:83], v[16:31]
  ds_read_b128 v[152:155], v1 offset:6144
  buffer_load_dwordx4 a[108:111], v1, s[8:11], s29 offen offset:3072 sc1
  v_mfma_f32_32x32x16_bf16 v[32:47], v[132:135], a[80:83], v[32:47]
  ds_read_b128 v[156:159], v1 offset:7168
  s_waitcnt lgkmcnt(4)
  v_mfma_f32_32x32x16_bf16 v[48:63], v[136:139], a[80:83], v[48:63]
  ds_read_b128 v[128:131], v1 offset:8192
  s_add_u32 s28, s40, 204800
  s_add_u32 m0, s41, 122880
  s_nop 0
  buffer_load_dwordx4 v1, s[8:11], s28 offen offset:0 sc1 lds
  v_mfma_f32_32x32x16_bf16 v[64:79], v[140:143], a[80:83], v[64:79]
  ds_read_b128 v[132:135], v1 offset:9216
  s_waitcnt vmcnt(13)
  s_waitcnt lgkmcnt(4)
  v_mfma_f32_32x32x16_bf16 v[16:31], v[144:147], a[84:87], v[16:31]
  ds_read_b128 v[136:139], v1 offset:10240
  s_add_u32 s29, s38, 13385728
  buffer_load_dwordx4 a[112:115], v1, s[8:11], s29 offen offset:0 sc1
  v_mfma_f32_32x32x16_bf16 v[32:47], v[148:151], a[84:87], v[32:47]
  ds_read_b128 v[140:143], v1 offset:11264
  s_waitcnt lgkmcnt(4)
  v_mfma_f32_32x32x16_bf16 v[48:63], v[152:155], a[84:87], v[48:63]
  ds_read_b128 v[144:147], v1 offset:12288
  buffer_load_dwordx4 v1, s[8:11], s28 offen offset:1024 sc1 lds
  v_mfma_f32_32x32x16_bf16 v[64:79], v[156:159], a[84:87], v[64:79]
  ds_read_b128 v[148:151], v1 offset:13312
  s_waitcnt vmcnt(13)
  s_waitcnt lgkmcnt(4)
  v_mfma_f32_32x32x16_bf16 v[16:31], v[128:131], a[88:91], v[16:31]
  ds_read_b128 v[152:155], v1 offset:14336
  buffer_load_dwordx4 a[116:119], v1, s[8:11], s29 offen offset:1024 sc1
  v_mfma_f32_32x32x16_bf16 v[32:47], v[132:135], a[88:91], v[32:47]
  ds_read_b128 v[156:159], v1 offset:15360
  s_waitcnt lgkmcnt(4)
  v_mfma_f32_32x32x16_bf16 v[48:63], v[136:139], a[88:91], v[48:63]
  ds_read_b128 v[128:131], v1 offset:16384
  buffer_load_dwordx4 v1, s[8:11], s28 offen offset:2048 sc1 lds
  v_mfma_f32_32x32x16_bf16 v[64:79], v[140:143], a[88:91], v[64:79]
  ds_read_b128 v[132:135], v1 offset:17408
  s_waitcnt vmcnt(13)
  s_waitcnt lgkmcnt(4)
  v_mfma_f32_32x32x16_bf16 v[16:31], v[144:147], a[92:95], v[16:31]
  ds_read_b128 v[136:139], v1 offset:18432
  buffer_load_dwordx4 a[120:123], v1, s[8:11], s29 offen offset:2048 sc1
  v_mfma_f32_32x32x16_bf16 v[32:47], v[148:151], a[92:95], v[32:47]
  ds_read_b128 v[140:143], v1 offset:19456
  s_waitcnt lgkmcnt(4)
  v_mfma_f32_32x32x16_bf16 v[48:63], v[152:155], a[92:95], v[48:63]
  s_barrier
  ds_read_b128 v[144:147], v1 offset:20480
  buffer_load_dwordx4 v1, s[8:11], s28 offen offset:3072 sc1 lds
  v_mfma_f32_32x32x16_bf16 v[64:79], v[156:159], a[92:95], v[64:79]
  ds_read_b128 v[148:151], v1 offset:21504
  s_waitcnt vmcnt(13)
  s_waitcnt lgkmcnt(4)
  v_mfma_f32_32x32x16_bf16 v[16:31], v[128:131], a[96:99], v[16:31]
  ds_read_b128 v[152:155], v1 offset:22528
  buffer_load_dwordx4 a[124:127], v1, s[8:11], s29 offen offset:3072 sc1
  v_mfma_f32_32x32x16_bf16 v[32:47], v[132:135], a[96:99], v[32:47]
  ds_read_b128 v[156:159], v1 offset:23552
  s_waitcnt lgkmcnt(4)
  v_mfma_f32_32x32x16_bf16 v[48:63], v[136:139], a[96:99], v[48:63]
  ds_read_b128 v[128:131], v1 offset:24576
  s_add_u32 s28, s40, 208896
  s_add_u32 m0, s41, 126976
  s_nop 0
  buffer_load_dwordx4 v1, s[8:11], s28 offen offset:0 sc1 lds
  v_mfma_f32_32x32x16_bf16 v[64:79], v[140:143], a[96:99], v[64:79]
  ds_read_b128 v[132:135], v1 offset:25600
  s_waitcnt vmcnt(13)
  s_waitcnt lgkmcnt(4)
  v_mfma_f32_32x32x16_bf16 v[16:31], v[144:147], a[100:103], v[16:31]
  ds_read_b128 v[136:139], v1 offset:26624
  s_add_u32 s29, s38, 13389824
  buffer_load_dwordx4 a[128:131], v1, s[8:11], s29 offen offset:0 sc1
  v_mfma_f32_32x32x16_bf16 v[32:47], v[148:151], a[100:103], v[32:47]
  ds_read_b128 v[140:143], v1 offset:27648
  s_waitcnt lgkmcnt(4)
  v_mfma_f32_32x32x16_bf16 v[48:63], v[152:155], a[100:103], v[48:63]
  ds_read_b128 v[144:147], v1 offset:28672
  s_add_u32 s28, s40, 225280
  s_add_u32 m0, s41, 143360
  s_nop 0
  buffer_load_dwordx4 v1, s[8:11], s28 offen offset:0 sc1 lds
  v_mfma_f32_32x32x16_bf16 v[64:79], v[156:159], a[100:103], v[64:79]
  ds_read_b128 v[148:151], v1 offset:29696
  s_waitcnt vmcnt(13)
  s_waitcnt lgkmcnt(4)
  v_mfma_f32_32x32x16_bf16 v[16:31], v[128:131], a[104:107], v[16:31]
  ds_read_b128 v[152:155], v1 offset:30720
  buffer_load_dwordx4 a[132:135], v1, s[8:11], s29 offen offset:1024 sc1
  v_mfma_f32_32x32x16_bf16 v[32:47], v[132:135], a[104:107], v[32:47]
  ds_read_b128 v[156:159], v1 offset:31744
  s_waitcnt lgkmcnt(4)
  v_mfma_f32_32x32x16_bf16 v[48:63], v[136:139], a[104:107], v[48:63]
  ds_read_b128 v[128:131], v1 offset:32768
  buffer_load_dwordx4 v1, s[8:11], s28 offen offset:1024 sc1 lds
  v_mfma_f32_32x32x16_bf16 v[64:79], v[140:143], a[104:107], v[64:79]
  ds_read_b128 v[132:135], v1 offset:33792
  s_waitcnt vmcnt(13)
  s_waitcnt lgkmcnt(4)
  v_mfma_f32_32x32x16_bf16 v[16:31], v[144:147], a[108:111], v[16:31]
  ds_read_b128 v[136:139], v1 offset:34816
  buffer_load_dwordx4 a[136:139], v1, s[8:11], s29 offen offset:2048 sc1
  v_mfma_f32_32x32x16_bf16 v[32:47], v[148:151], a[108:111], v[32:47]
  ds_read_b128 v[140:143], v1 offset:35840
  s_waitcnt lgkmcnt(4)
  v_mfma_f32_32x32x16_bf16 v[48:63], v[152:155], a[108:111], v[48:63]
  ds_read_b128 v[144:147], v1 offset:36864
  buffer_load_dwordx4 v1, s[8:11], s28 offen offset:2048 sc1 lds
  v_mfma_f32_32x32x16_bf16 v[64:79], v[156:159], a[108:111], v[64:79]
  ds_read_b128 v[148:151], v1 offset:37888
  s_waitcnt vmcnt(13)
  s_waitcnt lgkmcnt(4)
  v_mfma_f32_32x32x16_bf16 v[16:31], v[128:131], a[112:115], v[16:31]
  ds_read_b128 v[152:155], v1 offset:38912
  buffer_load_dwordx4 a[140:143], v1, s[8:11], s29 offen offset:3072 sc1
  v_mfma_f32_32x32x16_bf16 v[32:47], v[132:135], a[112:115], v[32:47]
  ds_read_b128 v[156:159], v1 offset:39936
  s_waitcnt lgkmcnt(4)
  v_mfma_f32_32x32x16_bf16 v[48:63], v[136:139], a[112:115], v[48:63]
  s_barrier
  ds_read_b128 v[128:131], v1 offset:40960
  buffer_load_dwordx4 v1, s[8:11], s28 offen offset:3072 sc1 lds
  v_mfma_f32_32x32x16_bf16 v[64:79], v[140:143], a[112:115], v[64:79]
  ds_read_b128 v[132:135], v1 offset:41984
  s_waitcnt vmcnt(13)
  s_waitcnt lgkmcnt(4)
  v_mfma_f32_32x32x16_bf16 v[16:31], v[144:147], a[116:119], v[16:31]
  ds_read_b128 v[136:139], v1 offset:43008
  s_add_u32 s29, s38, 13393920
  buffer_load_dwordx4 a[144:147], v1, s[8:11], s29 offen offset:0 sc1
  v_mfma_f32_32x32x16_bf16 v[32:47], v[148:151], a[116:119], v[32:47]
  ds_read_b128 v[140:143], v1 offset:44032
  s_waitcnt lgkmcnt(4)
  v_mfma_f32_32x32x16_bf16 v[48:63], v[152:155], a[116:119], v[48:63]
  ds_read_b128 v[144:147], v1 offset:45056
  s_add_u32 s28, s40, 229376
  s_add_u32 m0, s41, 147456
  s_nop 0
  buffer_load_dwordx4 v1, s[8:11], s28 offen offset:0 sc1 lds
  v_mfma_f32_32x32x16_bf16 v[64:79], v[156:159], a[116:119], v[64:79]
  ds_read_b128 v[148:151], v1 offset:46080
  s_waitcnt vmcnt(13)
  s_waitcnt lgkmcnt(4)
  v_mfma_f32_32x32x16_bf16 v[16:31], v[128:131], a[120:123], v[16:31]
  ds_read_b128 v[152:155], v1 offset:47104
  buffer_load_dwordx4 a[148:151], v1, s[8:11], s29 offen offset:1024 sc1
  v_mfma_f32_32x32x16_bf16 v[32:47], v[132:135], a[120:123], v[32:47]
  ds_read_b128 v[156:159], v1 offset:48128
  v_add_f32 v224, v224, v226
  v_add_f32 v225, v225, v227
  v_add_f32 v228, v228, v230
  s_waitcnt lgkmcnt(4)
  v_mfma_f32_32x32x16_bf16 v[48:63], v[136:139], a[120:123], v[48:63]
  ds_read_b128 v[128:131], v1 offset:49152
  s_add_u32 s28, s40, 245760
  s_add_u32 m0, s41, 0
  s_nop 0
  buffer_load_dwordx4 v1, s[8:11], s28 offen offset:0 sc1 lds
  v_mfma_f32_32x32x16_bf16 v[64:79], v[140:143], a[120:123], v[64:79]
  ds_read_b128 v[132:135], v1 offset:50176
  v_add_f32 v229, v229, v231
  v_add_f32 v224, v224, v228
  v_add_f32 v225, v225, v229
  s_waitcnt vmcnt(13)
  s_waitcnt lgkmcnt(4)
  v_mfma_f32_32x32x16_bf16 v[16:31], v[144:147], a[124:127], v[16:31]
  ds_read_b128 v[136:139], v1 offset:51200
  buffer_load_dwordx4 a[152:155], v1, s[8:11], s29 offen offset:2048 sc1
  v_mfma_f32_32x32x16_bf16 v[32:47], v[148:151], a[124:127], v[32:47]
  ds_read_b128 v[140:143], v1 offset:52224
  v_mov_b32 v226, v224
  v_mov_b32 v227, v225
  s_nop 0
  v_permlane32_swap_b32 v224, v226
  s_waitcnt lgkmcnt(4)
  v_mfma_f32_32x32x16_bf16 v[48:63], v[152:155], a[124:127], v[48:63]
  ds_read_b128 v[144:147], v1 offset:53248
  buffer_load_dwordx4 v1, s[8:11], s28 offen offset:1024 sc1 lds
  v_mfma_f32_32x32x16_bf16 v[64:79], v[156:159], a[124:127], v[64:79]
  ds_read_b128 v[148:151], v1 offset:54272
  v_permlane32_swap_b32 v225, v227
  v_add_f32 v224, v224, v226
  v_add_f32 v225, v225, v227
  s_waitcnt vmcnt(13)
  s_waitcnt lgkmcnt(4)
  v_mfma_f32_32x32x16_bf16 v[16:31], v[128:131], a[128:131], v[16:31]
  ds_read_b128 v[152:155], v1 offset:55296
  buffer_load_dwordx4 a[156:159], v1, s[8:11], s29 offen offset:3072 sc1
  v_mfma_f32_32x32x16_bf16 v[32:47], v[132:135], a[128:131], v[32:47]
  ds_read_b128 v[156:159], v1 offset:56320
  v_mul_f32 v224, 0xbacccccd, v224
  v_mul_f32 v225, 0x3acccccd, v225
  v_fma_f32 v225, -v224, v224, v225
  s_waitcnt lgkmcnt(4)
  v_mfma_f32_32x32x16_bf16 v[48:63], v[136:139], a[128:131], v[48:63]
  ds_read_b128 v[128:131], v1 offset:57344
  buffer_load_dwordx4 v1, s[8:11], s28 offen offset:2048 sc1 lds
  v_mfma_f32_32x32x16_bf16 v[64:79], v[140:143], a[128:131], v[64:79]
  ds_read_b128 v[132:135], v1 offset:58368
  v_cvt_pk_bf16_f32 v230, v224, v224
  v_max_f32 v225, 0, v225
  v_and_b32 v226, 0xffff0000, v230
  s_waitcnt vmcnt(13)
  s_waitcnt lgkmcnt(4)
  v_mfma_f32_32x32x16_bf16 v[16:31], v[144:147], a[132:135], v[16:31]
  ds_read_b128 v[136:139], v1 offset:59392
  buffer_load_dwordx4 v1, s[8:11], s28 offen offset:3072 sc1 lds
  v_mfma_f32_32x32x16_bf16 v[32:47], v[148:151], a[132:135], v[32:47]
  ds_read_b128 v[140:143], v1 offset:60416
  v_add_f32 v225, 0x3727c5ac, v225
  v_sub_f32 v226, v224, v226
  v_rsq_f32 v232, v225
  s_waitcnt lgkmcnt(4)
  v_mfma_f32_32x32x16_bf16 v[48:63], v[152:155], a[132:135], v[48:63]
  s_barrier
  ds_read_b128 v[144:147], v1 offset:61440
  s_add_u32 s28, s40, 249856
  s_add_u32 m0, s41, 4096
  s_nop 0
  buffer_load_dwordx4 v1, s[8:11], s28 offen offset:0 sc1 lds
  v_mfma_f32_32x32x16_bf16 v[64:79], v[156:159], a[132:135], v[64:79]
  ds_read_b128 v[148:151], v1 offset:62464
  v_cvt_pk_bf16_f32 v231, v226, v4
  v_mul_f32 v233, 0xbfb8aa3b, v232
  s_waitcnt vmcnt(13)
  s_waitcnt lgkmcnt(4)
  v_mfma_f32_32x32x16_bf16 v[16:31], v[128:131], a[136:139], v[16:31]
  ds_read_b128 v[152:155], v1 offset:63488
  s_add_u32 s28, s40, 266240
  s_add_u32 m0, s41, 20480
  s_nop 0
  buffer_load_dwordx4 v1, s[8:11], s28 offen offset:0 sc1 lds
  v_mfma_f32_32x32x16_bf16 v[32:47], v[132:135], a[136:139], v[32:47]
  ds_read_b128 v[156:159], v1 offset:64512
  v_mov_b32 v232, v225
  s_waitcnt lgkmcnt(4)
  v_mfma_f32_32x32x16_bf16 v[48:63], v[136:139], a[136:139], v[48:63]
  ds_read_b128 v[128:131], v2 offset:0
  buffer_load_dwordx4 v1, s[8:11], s28 offen offset:1024 sc1 lds
  v_mfma_f32_32x32x16_bf16 v[64:79], v[140:143], a[136:139], v[64:79]
  ds_read_b128 v[132:135], v2 offset:1024
  s_waitcnt vmcnt(13)
  s_waitcnt lgkmcnt(4)
  v_mfma_f32_32x32x16_bf16 v[16:31], v[144:147], a[140:143], v[16:31]
  ds_read_b128 v[136:139], v2 offset:2048
  buffer_load_dwordx4 v1, s[8:11], s28 offen offset:2048 sc1 lds
  v_mfma_f32_32x32x16_bf16 v[32:47], v[148:151], a[140:143], v[32:47]
  ds_read_b128 v[140:143], v2 offset:3072
  s_waitcnt lgkmcnt(4)
  v_mfma_f32_32x32x16_bf16 v[48:63], v[152:155], a[140:143], v[48:63]
  ds_read_b128 v[144:147], v2 offset:4096
  buffer_load_dwordx4 v1, s[8:11], s28 offen offset:3072 sc1 lds
  v_mfma_f32_32x32x16_bf16 v[64:79], v[156:159], a[140:143], v[64:79]
  ds_read_b128 v[148:151], v2 offset:5120
  s_waitcnt vmcnt(13)
  s_waitcnt lgkmcnt(4)
  v_mfma_f32_32x32x16_bf16 v[16:31], v[128:131], a[144:147], v[16:31]
  ds_read_b128 v[152:155], v2 offset:6144
  s_add_u32 s28, s40, 270336
  s_add_u32 m0, s41, 24576
  s_nop 0
  buffer_load_dwordx4 v1, s[8:11], s28 offen offset:0 sc1 lds
  v_mfma_f32_32x32x16_bf16 v[32:47], v[132:135], a[144:147], v[32:47]
  ds_read_b128 v[156:159], v2 offset:7168
  s_waitcnt lgkmcnt(4)
  v_mfma_f32_32x32x16_bf16 v[48:63], v[136:139], a[144:147], v[48:63]
  ds_read_b128 v[128:131], v2 offset:8192
  buffer_load_dwordx4 a[188:191], v1, s[8:11], s27 offen offset:2048 sc1
  v_mfma_f32_32x32x16_bf16 v[64:79], v[140:143], a[144:147], v[64:79]
  ds_read_b128 v[132:135], v2 offset:9216
  s_waitcnt vmcnt(13)
  s_waitcnt lgkmcnt(4)
  v_mfma_f32_32x32x16_bf16 v[16:31], v[144:147], a[148:151], v[16:31]
  ds_read_b128 v[136:139], v2 offset:10240
  buffer_load_dwordx4 a[192:195], v1, s[8:11], s27 offen offset:3072 sc1
  v_mfma_f32_32x32x16_bf16 v[32:47], v[148:151], a[148:151], v[32:47]
  ds_read_b128 v[140:143], v2 offset:11264
  s_waitcnt lgkmcnt(4)
  v_mfma_f32_32x32x16_bf16 v[48:63], v[152:155], a[148:151], v[48:63]
  ds_read_b128 v[144:147], v2 offset:12288
  s_add_u32 s27, s52, 9216
  buffer_load_dwordx4 a[196:199], v1, s[8:11], s27 offen offset:0 sc1
  v_mfma_f32_32x32x16_bf16 v[64:79], v[156:159], a[148:151], v[64:79]
  ds_read_b128 v[148:151], v2 offset:13312
  s_waitcnt vmcnt(13)
  s_waitcnt lgkmcnt(4)
  v_mfma_f32_32x32x16_bf16 v[16:31], v[128:131], a[152:155], v[16:31]
  ds_read_b128 v[152:155], v2 offset:14336
  s_add_u32 s27, s52, 10240
  buffer_load_dwordx4 a[200:203], v1, s[8:11], s27 offen offset:0 sc1
  v_mfma_f32_32x32x16_bf16 v[32:47], v[132:135], a[152:155], v[32:47]
  ds_read_b128 v[156:159], v2 offset:15360
  s_waitcnt lgkmcnt(4)
  v_mfma_f32_32x32x16_bf16 v[48:63], v[136:139], a[152:155], v[48:63]
  s_barrier
  ds_read_b128 v[128:131], v2 offset:16384
  buffer_load_dwordx4 a[204:207], v1, s[8:11], s27 offen offset:1024 sc1
  v_mfma_f32_32x32x16_bf16 v[64:79], v[140:143], a[152:155], v[64:79]
  ds_read_b128 v[132:135], v2 offset:17408
  s_waitcnt vmcnt(13)
  s_waitcnt lgkmcnt(4)
  v_mfma_f32_32x32x16_bf16 v[16:31], v[144:147], a[156:159], v[16:31]
  ds_read_b128 v[136:139], v2 offset:18432
  buffer_load_dwordx4 a[208:211], v1, s[8:11], s27 offen offset:2048 sc1
  v_mfma_f32_32x32x16_bf16 v[32:47], v[148:151], a[156:159], v[32:47]
  ds_read_b128 v[140:143], v2 offset:19456
  s_waitcnt lgkmcnt(4)
  v_mfma_f32_32x32x16_bf16 v[48:63], v[152:155], a[156:159], v[48:63]
  ds_read_b128 v[144:147], v2 offset:20480
  buffer_load_dwordx4 a[212:215], v1, s[8:11], s27 offen offset:3072 sc1
  v_mfma_f32_32x32x16_bf16 v[64:79], v[156:159], a[156:159], v[64:79]
  ds_read_b128 v[148:151], v2 offset:21504
  v_mfma_f32_32x32x8_bf16 v[16:31], v[176:177], v[230:231], v[16:31]
  v_mfma_f32_32x32x8_bf16 v[32:47], v[178:179], v[230:231], v[32:47]
  v_mfma_f32_32x32x8_bf16 v[48:63], v[180:181], v[230:231], v[48:63]
  v_mfma_f32_32x32x8_bf16 v[64:79], v[182:183], v[230:231], v[64:79]
  s_waitcnt lgkmcnt(4)
  v_mfma_f32_32x32x16_bf16 v[80:95], v[128:131], a[0:3], 0
  ds_read_b128 v[152:155], v2 offset:22528
  s_add_u32 s27, s52, 14336
  buffer_load_dwordx4 a[216:219], v1, s[8:11], s27 offen offset:0 sc1
  v_mfma_f32_32x32x16_bf16 v[96:111], v[132:135], a[0:3], 0
  ds_read_b128 v[156:159], v2 offset:23552
  s_nop 1
  v_mul_f32 v160, v16, v233
  s_waitcnt lgkmcnt(4)
  v_mfma_f32_32x32x16_bf16 v[112:127], v[136:139], a[0:3], 0
  ds_read_b128 v[128:131], v2 offset:24576
  s_add_u32 s27, s52, 15360
  buffer_load_dwordx4 a[220:223], v1, s[8:11], s27 offen offset:0 sc1
  v_mul_f32 v16, v16, v24
  v_mul_f32 v161, v17, v233
  v_mul_f32 v17, v17, v25
  v_mfma_f32_32x32x16_bf16 v[80:95], v[140:143], a[4:7], v[80:95]
  ds_read_b128 v[132:135], v2 offset:25600
  v_mul_f32 v162, v18, v233
  v_mul_f32 v18, v18, v26
  v_mul_f32 v163, v19, v233
  v_mul_f32 v19, v19, v27
  v_mul_f32 v164, v20, v233
  s_waitcnt lgkmcnt(4)
  v_mfma_f32_32x32x16_bf16 v[96:111], v[144:147], a[4:7], v[96:111]
  ds_read_b128 v[136:139], v2 offset:26624
  buffer_load_dwordx4 a[224:227], v1, s[8:11], s27 offen offset:1024 sc1
  v_mul_f32 v20, v20, v28
  v_mul_f32 v165, v21, v233
  v_mul_f32 v21, v21, v29
  v_mfma_f32_32x32x16_bf16 v[112:127], v[148:151], a[4:7], v[112:127]
  ds_read_b128 v[140:143], v2 offset:27648
  v_mul_f32 v166, v22, v233
  v_mul_f32 v22, v22, v30
  v_mul_f32 v167, v23, v233
  v_mul_f32 v23, v23, v31
  v_exp_f32 v160, v160
  s_waitcnt lgkmcnt(4)
  v_mfma_f32_32x32x16_bf16 v[80:95], v[152:155], a[8:11], v[80:95]
  ds_read_b128 v[144:147], v2 offset:28672
  buffer_load_dwordx4 a[228:231], v1, s[8:11], s27 offen offset:2048 sc1
  v_exp_f32 v161, v161
  v_exp_f32 v162, v162
  v_mfma_f32_32x32x16_bf16 v[96:111], v[156:159], a[8:11], v[96:111]
  ds_read_b128 v[148:151], v2 offset:29696
  v_exp_f32 v163, v163
  v_exp_f32 v164, v164
  s_waitcnt lgkmcnt(4)
  v_mfma_f32_32x32x16_bf16 v[112:127], v[128:131], a[8:11], v[112:127]
  ds_read_b128 v[152:155], v2 offset:30720
  buffer_load_dwordx4 a[232:235], v1, s[8:11], s27 offen offset:3072 sc1
  v_exp_f32 v165, v165
  v_exp_f32 v166, v166
  v_mfma_f32_32x32x16_bf16 v[80:95], v[132:135], a[12:15], v[80:95]
  ds_read_b128 v[156:159], v2 offset:31744
  v_exp_f32 v167, v167
  v_fma_f32 v160, v160, v232, v232
  v_fma_f32 v161, v161, v232, v232
  v_fma_f32 v162, v162, v232, v232
  s_waitcnt lgkmcnt(4)
  v_mfma_f32_32x32x16_bf16 v[96:111], v[136:139], a[12:15], v[96:111]
  ds_read_b128 v[128:131], v2 offset:32768
  s_add_u32 s27, s52, 19456
  buffer_load_dwordx4 a[236:239], v1, s[8:11], s27 offen offset:0 sc1
  v_fma_f32 v163, v163, v232, v232
  v_fma_f32 v164, v164, v232, v232
  v_fma_f32 v165, v165, v232, v232
  v_mfma_f32_32x32x16_bf16 v[112:127], v[140:143], a[12:15], v[112:127]
  ds_read_b128 v[132:135], v2 offset:33792
  v_fma_f32 v166, v166, v232, v232
  v_fma_f32 v167, v167, v232, v232
  v_rcp_f32 v160, v160
  v_rcp_f32 v161, v161
  s_waitcnt lgkmcnt(4)
  v_mfma_f32_32x32x16_bf16 v[80:95], v[144:147], a[16:19], v[80:95]
  ds_read_b128 v[136:139], v2 offset:34816
  v_rcp_f32 v162, v162
  v_mfma_f32_32x32x16_bf16 v[96:111], v[148:151], a[16:19], v[96:111]
  ds_read_b128 v[140:143], v2 offset:35840
  v_rcp_f32 v163, v163
  v_rcp_f32 v164, v164
  v_rcp_f32 v165, v165
  s_waitcnt lgkmcnt(4)
  v_mfma_f32_32x32x16_bf16 v[112:127], v[152:155], a[16:19], v[112:127]
  s_barrier
  ds_read_b128 v[144:147], v2 offset:36864
  v_rcp_f32 v166, v166
  v_rcp_f32 v167, v167
  v_mfma_f32_32x32x16_bf16 v[80:95], v[156:159], a[20:23], v[80:95]
  ds_read_b128 v[148:151], v2 offset:37888
  v_mul_f32 v16, v16, v160
  v_mul_f32 v17, v17, v161
  v_mul_f32 v18, v18, v162
  v_mul_f32 v19, v19, v163
  s_waitcnt lgkmcnt(4)
  v_mfma_f32_32x32x16_bf16 v[96:111], v[128:131], a[20:23], v[96:111]
  ds_read_b128 v[152:155], v2 offset:38912
  s_add_u32 s27, s52, 25600
  buffer_load_dwordx4 a[0:3], v1, s[8:11], s27 offen offset:0 sc1
  v_mul_f32 v20, v20, v164
  v_mul_f32 v21, v21, v165
  v_mul_f32 v22, v22, v166
  v_mfma_f32_32x32x16_bf16 v[112:127], v[132:135], a[20:23], v[112:127]
  ds_read_b128 v[156:159], v2 offset:39936
  v_mul_f32 v23, v23, v167
  v_cvt_pk_bf16_f32 v24, v16, v17
  v_cvt_pk_bf16_f32 v25, v18, v19
  v_cvt_pk_bf16_f32 v26, v20, v21
  v_cvt_pk_bf16_f32 v27, v22, v23
  buffer_store_dwordx4 v[24:27], v9, s[8:11], s42 offen offset:0 sc1
  s_waitcnt lgkmcnt(4)
  v_mfma_f32_32x32x16_bf16 v[80:95], v[136:139], a[24:27], v[80:95]
  ds_read_b128 v[128:131], v2 offset:40960
  buffer_load_dwordx4 a[4:7], v1, s[8:11], s27 offen offset:1024 sc1
  v_mul_f32 v160, v32, v233
  v_mul_f32 v32, v32, v40
  v_mfma_f32_32x32x16_bf16 v[96:111], v[140:143], a[24:27], v[96:111]
  ds_read_b128 v[132:135], v2 offset:41984
  v_mul_f32 v161, v33, v233
  v_mul_f32 v33, v33, v41
  v_mul_f32 v162, v34, v233
  v_mul_f32 v34, v34, v42
  v_mul_f32 v163, v35, v233
  s_waitcnt lgkmcnt(4)
  v_mfma_f32_32x32x16_bf16 v[112:127], v[144:147], a[24:27], v[112:127]
  ds_read_b128 v[136:139], v2 offset:43008
  buffer_load_dwordx4 a[8:11], v1, s[8:11], s27 offen offset:2048 sc1
  v_mul_f32 v35, v35, v43
  v_mul_f32 v164, v36, v233
  v_mul_f32 v36, v36, v44
  v_mfma_f32_32x32x16_bf16 v[80:95], v[148:151], a[28:31], v[80:95]
  ds_read_b128 v[140:143], v2 offset:44032
  v_mul_f32 v165, v37, v233
  v_mul_f32 v37, v37, v45
  v_mul_f32 v166, v38, v233
  v_mul_f32 v38, v38, v46
  v_mul_f32 v167, v39, v233
  v_mul_f32 v39, v39, v47
  s_waitcnt lgkmcnt(4)
  v_mfma_f32_32x32x16_bf16 v[96:111], v[152:155], a[28:31], v[96:111]
  ds_read_b128 v[144:147], v2 offset:45056
  buffer_load_dwordx4 a[12:15], v1, s[8:11], s27 offen offset:3072 sc1
  v_exp_f32 v160, v160
  v_exp_f32 v161, v161
  v_mfma_f32_32x32x16_bf16 v[112:127], v[156:159], a[28:31], v[112:127]
  ds_read_b128 v[148:151], v2 offset:46080
  v_exp_f32 v162, v162
  v_exp_f32 v163, v163
  s_waitcnt lgkmcnt(4)
  v_mfma_f32_32x32x16_bf16 v[80:95], v[128:131], a[32:35], v[80:95]
  ds_read_b128 v[152:155], v2 offset:47104
  s_add_u32 s27, s52, 29696
  buffer_load_dwordx4 a[16:19], v1, s[8:11], s27 offen offset:0 sc1
  v_exp_f32 v164, v164
  v_exp_f32 v165, v165
  v_mfma_f32_32x32x16_bf16 v[96:111], v[132:135], a[32:35], v[96:111]
  ds_read_b128 v[156:159], v2 offset:48128
  v_exp_f32 v166, v166
  v_exp_f32 v167, v167
  v_fma_f32 v160, v160, v232, v232
  s_waitcnt lgkmcnt(4)
  v_mfma_f32_32x32x16_bf16 v[112:127], v[136:139], a[32:35], v[112:127]
  ds_read_b128 v[128:131], v2 offset:49152
  v_fma_f32 v161, v161, v232, v232
  v_fma_f32 v162, v162, v232, v232
  v_fma_f32 v163, v163, v232, v232
  v_mfma_f32_32x32x16_bf16 v[80:95], v[140:143], a[36:39], v[80:95]
  ds_read_b128 v[132:135], v2 offset:50176
  v_fma_f32 v164, v164, v232, v232
  v_fma_f32 v165, v165, v232, v232
  v_fma_f32 v166, v166, v232, v232
  v_fma_f32 v167, v167, v232, v232
  v_rcp_f32 v160, v160
  s_waitcnt lgkmcnt(4)
  v_mfma_f32_32x32x16_bf16 v[96:111], v[144:147], a[36:39], v[96:111]
  ds_read_b128 v[136:139], v2 offset:51200
  v_rcp_f32 v161, v161
  v_mfma_f32_32x32x16_bf16 v[112:127], v[148:151], a[36:39], v[112:127]
  ds_read_b128 v[140:143], v2 offset:52224
  v_rcp_f32 v162, v162
  v_rcp_f32 v163, v163
  v_rcp_f32 v164, v164
  s_waitcnt lgkmcnt(4)
  v_mfma_f32_32x32x16_bf16 v[80:95], v[152:155], a[40:43], v[80:95]
  ds_read_b128 v[144:147], v2 offset:53248
  s_add_u32 s27, s52, 30720
  buffer_load_dwordx4 a[20:23], v1, s[8:11], s27 offen offset:0 sc1
  v_rcp_f32 v165, v165
  v_rcp_f32 v166, v166
  v_mfma_f32_32x32x16_bf16 v[96:111], v[156:159], a[40:43], v[96:111]
  ds_read_b128 v[148:151], v2 offset:54272
  v_rcp_f32 v167, v167
  v_mul_f32 v32, v32, v160
  v_mul_f32 v33, v33, v161
  s_waitcnt lgkmcnt(4)
  v_mfma_f32_32x32x16_bf16 v[112:127], v[128:131], a[40:43], v[112:127]
  ds_read_b128 v[152:155], v2 offset:55296
  buffer_load_dwordx4 a[24:27], v1, s[8:11], s27 offen offset:1024 sc1
  v_mul_f32 v34, v34, v162
  v_mul_f32 v35, v35, v163
  v_mul_f32 v36, v36, v164
  v_mfma_f32_32x32x16_bf16 v[80:95], v[132:135], a[44:47], v[80:95]
  ds_read_b128 v[156:159], v2 offset:56320
  v_mul_f32 v37, v37, v165
  v_mul_f32 v38, v38, v166
  v_mul_f32 v39, v39, v167
  v_cvt_pk_bf16_f32 v40, v32, v33
  v_cvt_pk_bf16_f32 v41, v34, v35
  v_cvt_pk_bf16_f32 v42, v36, v37
  s_waitcnt lgkmcnt(4)
  v_mfma_f32_32x32x16_bf16 v[96:111], v[136:139], a[44:47], v[96:111]
  s_barrier
  ds_read_b128 v[128:131], v2 offset:57344
  buffer_load_dwordx4 a[28:31], v1, s[8:11], s27 offen offset:2048 sc1
  v_cvt_pk_bf16_f32 v43, v38, v39
  buffer_store_dwordx4 v[40:43], v9, s[8:11], s42 offen offset:512 sc1
  v_mfma_f32_32x32x16_bf16 v[112:127], v[140:143], a[44:47], v[112:127]
  ds_read_b128 v[132:135], v2 offset:58368
  v_mul_f32 v160, v48, v233
  v_mul_f32 v48, v48, v56
  v_mul_f32 v161, v49, v233
  v_mul_f32 v49, v49, v57
  v_mul_f32 v162, v50, v233
  s_waitcnt lgkmcnt(4)
  v_mfma_f32_32x32x16_bf16 v[80:95], v[144:147], a[48:51], v[80:95]
  ds_read_b128 v[136:139], v2 offset:59392
  buffer_load_dwordx4 a[32:35], v1, s[8:11], s27 offen offset:3072 sc1
  v_mul_f32 v50, v50, v58
  v_mul_f32 v163, v51, v233
  v_mul_f32 v51, v51, v59
  v_mfma_f32_32x32x16_bf16 v[96:111], v[148:151], a[48:51], v[96:111]
  ds_read_b128 v[140:143], v2 offset:60416
  v_mul_f32 v164, v52, v233
  v_mul_f32 v52, v52, v60
  v_mul_f32 v165, v53, v233
  v_mul_f32 v53, v53, v61
  v_mul_f32 v166, v54, v233
  v_mul_f32 v54, v54, v62
  s_waitcnt lgkmcnt(4)
  v_mfma_f32_32x32x16_bf16 v[112:127], v[152:155], a[48:51], v[112:127]
  ds_read_b128 v[144:147], v2 offset:61440
  s_add_u32 s27, s52, 34816
  buffer_load_dwordx4 a[36:39], v1, s[8:11], s27 offen offset:0 sc1
  v_mul_f32 v167, v55, v233
  v_mul_f32 v55, v55, v63
  v_exp_f32 v160, v160
  v_mfma_f32_32x32x16_bf16 v[80:95], v[156:159], a[52:55], v[80:95]
  ds_read_b128 v[148:151], v2 offset:62464
  v_exp_f32 v161, v161
  v_exp_f32 v162, v162
  s_waitcnt lgkmcnt(4)
  v_mfma_f32_32x32x16_bf16 v[96:111], v[128:131], a[52:55], v[96:111]
  ds_read_b128 v[152:155], v2 offset:63488
  v_exp_f32 v163, v163
  v_exp_f32 v164, v164
  v_mfma_f32_32x32x16_bf16 v[112:127], v[132:135], a[52:55], v[112:127]
  ds_read_b128 v[156:159], v2 offset:64512
  v_exp_f32 v165, v165
  v_exp_f32 v166, v166
  v_exp_f32 v167, v167
  s_waitcnt lgkmcnt(4)
  v_mfma_f32_32x32x16_bf16 v[80:95], v[136:139], a[56:59], v[80:95]
  ds_read_b128 v[128:131], v3 offset:0
  v_fma_f32 v160, v160, v232, v232
  v_fma_f32 v161, v161, v232, v232
  v_mfma_f32_32x32x16_bf16 v[96:111], v[140:143], a[56:59], v[96:111]
  ds_read_b128 v[132:135], v3 offset:1024
  v_fma_f32 v162, v162, v232, v232
  v_fma_f32 v163, v163, v232, v232
  v_fma_f32 v164, v164, v232, v232
  v_fma_f32 v165, v165, v232, v232
  v_fma_f32 v166, v166, v232, v232
  s_waitcnt lgkmcnt(4)
  v_mfma_f32_32x32x16_bf16 v[112:127], v[144:147], a[56:59], v[112:127]
  ds_read_b128 v[136:139], v3 offset:2048
  v_fma_f32 v167, v167, v232, v232
  v_rcp_f32 v160, v160
  v_mfma_f32_32x32x16_bf16 v[80:95], v[148:151], a[60:63], v[80:95]
  ds_read_b128 v[140:143], v3 offset:3072
  v_rcp_f32 v161, v161
  v_rcp_f32 v162, v162
  v_rcp_f32 v163, v163
  s_waitcnt lgkmcnt(4)
  v_mfma_f32_32x32x16_bf16 v[96:111], v[152:155], a[60:63], v[96:111]
  ds_read_b128 v[144:147], v3 offset:4096
  s_add_u32 s27, s52, 35840
  buffer_load_dwordx4 a[40:43], v1, s[8:11], s27 offen offset:0 sc1
  v_rcp_f32 v164, v164
  v_rcp_f32 v165, v165
  v_mfma_f32_32x32x16_bf16 v[112:127], v[156:159], a[60:63], v[112:127]
  ds_read_b128 v[148:151], v3 offset:5120
  v_rcp_f32 v166, v166
  v_rcp_f32 v167, v167
  s_waitcnt lgkmcnt(4)
  v_mfma_f32_32x32x16_bf16 v[80:95], v[128:131], a[64:67], v[80:95]
  ds_read_b128 v[152:155], v3 offset:6144
  buffer_load_dwordx4 a[44:47], v1, s[8:11], s27 offen offset:1024 sc1
  v_mul_f32 v48, v48, v160
  v_mul_f32 v49, v49, v161
  v_mul_f32 v50, v50, v162
  v_mfma_f32_32x32x16_bf16 v[96:111], v[132:135], a[64:67], v[96:111]
  ds_read_b128 v[156:159], v3 offset:7168
  v_mul_f32 v51, v51, v163
  v_mul_f32 v52, v52, v164
  v_mul_f32 v53, v53, v165
  v_mul_f32 v54, v54, v166
  v_mul_f32 v55, v55, v167
  v_cvt_pk_bf16_f32 v56, v48, v49
  s_waitcnt lgkmcnt(4)
  v_mfma_f32_32x32x16_bf16 v[112:127], v[136:139], a[64:67], v[112:127]
  ds_read_b128 v[128:131], v3 offset:8192
  buffer_load_dwordx4 a[48:51], v1, s[8:11], s27 offen offset:2048 sc1
  v_cvt_pk_bf16_f32 v57, v50, v51
  v_cvt_pk_bf16_f32 v58, v52, v53
  v_cvt_pk_bf16_f32 v59, v54, v55
  v_mfma_f32_32x32x16_bf16 v[80:95], v[140:143], a[68:71], v[80:95]
  ds_read_b128 v[132:135], v3 offset:9216
  buffer_store_dwordx4 v[56:59], v9, s[8:11], s42 offen offset:1024 sc1
  v_mul_f32 v160, v64, v233
  v_mul_f32 v64, v64, v72
  v_mul_f32 v161, v65, v233
  s_waitcnt lgkmcnt(4)
  v_mfma_f32_32x32x16_bf16 v[96:111], v[144:147], a[68:71], v[96:111]
  ds_read_b128 v[136:139], v3 offset:10240
  buffer_load_dwordx4 a[52:55], v1, s[8:11], s27 offen offset:3072 sc1
  v_mul_f32 v65, v65, v73
  v_mul_f32 v162, v66, v233
  v_mul_f32 v66, v66, v74
  v_mfma_f32_32x32x16_bf16 v[112:127], v[148:151], a[68:71], v[112:127]
  ds_read_b128 v[140:143], v3 offset:11264
  v_mul_f32 v163, v67, v233
  v_mul_f32 v67, v67, v75
  v_mul_f32 v164, v68, v233
  v_mul_f32 v68, v68, v76
  v_mul_f32 v165, v69, v233
  v_mul_f32 v69, v69, v77
  s_waitcnt lgkmcnt(4)
  v_mfma_f32_32x32x16_bf16 v[80:95], v[152:155], a[72:75], v[80:95]
  s_barrier
  ds_read_b128 v[144:147], v3 offset:12288
  s_add_u32 s27, s52, 39936
  buffer_load_dwordx4 a[56:59], v1, s[8:11], s27 offen offset:0 sc1
  v_mul_f32 v166, v70, v233
  v_mul_f32 v70, v70, v78
  v_mul_f32 v167, v71, v233
  v_mfma_f32_32x32x16_bf16 v[96:111], v[156:159], a[72:75], v[96:111]
  ds_read_b128 v[148:151], v3 offset:13312
  v_mul_f32 v71, v71, v79
  v_exp_f32 v160, v160
  v_exp_f32 v161, v161
  s_waitcnt lgkmcnt(4)
  v_mfma_f32_32x32x16_bf16 v[112:127], v[128:131], a[72:75], v[112:127]
  ds_read_b128 v[152:155], v3 offset:14336
  v_exp_f32 v162, v162
  v_exp_f32 v163, v163
  v_mfma_f32_32x32x16_bf16 v[80:95], v[132:135], a[76:79], v[80:95]
  ds_read_b128 v[156:159], v3 offset:15360
  v_exp_f32 v164, v164
  v_exp_f32 v165, v165
  v_exp_f32 v166, v166
  s_waitcnt lgkmcnt(4)
  v_mfma_f32_32x32x16_bf16 v[96:111], v[136:139], a[76:79], v[96:111]
  ds_read_b128 v[128:131], v3 offset:16384
  v_exp_f32 v167, v167
  v_mfma_f32_32x32x16_bf16 v[112:127], v[140:143], a[76:79], v[112:127]
  ds_read_b128 v[132:135], v3 offset:17408
  v_fma_f32 v160, v160, v232, v232
  v_fma_f32 v161, v161, v232, v232
  v_fma_f32 v162, v162, v232, v232
  v_fma_f32 v163, v163, v232, v232
  v_fma_f32 v164, v164, v232, v232
  s_waitcnt lgkmcnt(4)
  v_mfma_f32_32x32x16_bf16 v[80:95], v[144:147], a[80:83], v[80:95]
  ds_read_b128 v[136:139], v3 offset:18432
  s_add_u32 s27, s52, 40960
  buffer_load_dwordx4 a[60:63], v1, s[8:11], s27 offen offset:0 sc1
  v_fma_f32 v165, v165, v232, v232
  v_fma_f32 v166, v166, v232, v232
  v_fma_f32 v167, v167, v232, v232
  v_mfma_f32_32x32x16_bf16 v[96:111], v[148:151], a[80:83], v[96:111]
  ds_read_b128 v[140:143], v3 offset:19456
  v_rcp_f32 v160, v160
  v_rcp_f32 v161, v161
  v_rcp_f32 v162, v162
  s_waitcnt lgkmcnt(4)
  v_mfma_f32_32x32x16_bf16 v[112:127], v[152:155], a[80:83], v[112:127]
  ds_read_b128 v[144:147], v3 offset:20480
  buffer_load_dwordx4 a[64:67], v1, s[8:11], s27 offen offset:1024 sc1
  v_rcp_f32 v163, v163
  v_rcp_f32 v164, v164
  v_mfma_f32_32x32x16_bf16 v[80:95], v[156:159], a[84:87], v[80:95]
  ds_read_b128 v[148:151], v3 offset:21504
  v_rcp_f32 v165, v165
  v_rcp_f32 v166, v166
  s_waitcnt lgkmcnt(4)
  v_mfma_f32_32x32x16_bf16 v[96:111], v[128:131], a[84:87], v[96:111]
  ds_read_b128 v[152:155], v3 offset:22528
  buffer_load_dwordx4 a[68:71], v1, s[8:11], s27 offen offset:2048 sc1
  v_rcp_f32 v167, v167
  v_mul_f32 v64, v64, v160
  v_mfma_f32_32x32x16_bf16 v[112:127], v[132:135], a[84:87], v[112:127]
  ds_read_b128 v[156:159], v3 offset:23552
  v_mul_f32 v65, v65, v161
  v_mul_f32 v66, v66, v162
  v_mul_f32 v67, v67, v163
  v_mul_f32 v68, v68, v164
  v_mul_f32 v69, v69, v165
  v_mul_f32 v70, v70, v166
  s_waitcnt lgkmcnt(4)
  v_mfma_f32_32x32x16_bf16 v[80:95], v[136:139], a[88:91], v[80:95]
  ds_read_b128 v[128:131], v3 offset:24576
  buffer_load_dwordx4 a[72:75], v1, s[8:11], s27 offen offset:3072 sc1
  v_mul_f32 v71, v71, v167
  v_cvt_pk_bf16_f32 v72, v64, v65
  v_cvt_pk_bf16_f32 v73, v66, v67
  v_mfma_f32_32x32x16_bf16 v[96:111], v[140:143], a[88:91], v[96:111]
  ds_read_b128 v[132:135], v3 offset:25600
  v_cvt_pk_bf16_f32 v74, v68, v69
  v_cvt_pk_bf16_f32 v75, v70, v71
  buffer_store_dwordx4 v[72:75], v9, s[8:11], s42 offen offset:1536 sc1
  s_waitcnt lgkmcnt(4)
  v_mfma_f32_32x32x16_bf16 v[112:127], v[144:147], a[88:91], v[112:127]
  ds_read_b128 v[136:139], v3 offset:26624
  s_add_u32 s27, s52, 45056
  buffer_load_dwordx4 a[76:79], v1, s[8:11], s27 offen offset:0 sc1
  v_mfma_f32_32x32x16_bf16 v[80:95], v[148:151], a[92:95], v[80:95]
  ds_read_b128 v[140:143], v3 offset:27648
  s_waitcnt lgkmcnt(4)
  v_mfma_f32_32x32x16_bf16 v[96:111], v[152:155], a[92:95], v[96:111]
  ds_read_b128 v[144:147], v3 offset:28672
  s_add_u32 s27, s52, 56320
  buffer_load_dwordx4 v[16:19], v1, s[8:11], s27 offen offset:0 sc1
  v_mfma_f32_32x32x16_bf16 v[112:127], v[156:159], a[92:95], v[112:127]
  ds_read_b128 v[148:151], v3 offset:29696
  s_waitcnt lgkmcnt(4)
  v_mfma_f32_32x32x16_bf16 v[80:95], v[128:131], a[96:99], v[80:95]
  ds_read_b128 v[152:155], v3 offset:30720
  buffer_load_dwordx4 v[20:23], v1, s[8:11], s27 offen offset:1024 sc1
  v_mfma_f32_32x32x16_bf16 v[96:111], v[132:135], a[96:99], v[96:111]
  ds_read_b128 v[156:159], v3 offset:31744
  s_waitcnt lgkmcnt(4)
  v_mfma_f32_32x32x16_bf16 v[112:127], v[136:139], a[96:99], v[112:127]
  s_waitcnt vmcnt(44)
  s_barrier
  ds_read_b128 v[128:131], v1 offset:0
  buffer_load_dwordx4 v[24:27], v1, s[8:11], s27 offen offset:2048 sc1
  v_mfma_f32_32x32x16_bf16 v[80:95], v[140:143], a[100:103], v[80:95]
  ds_read_b128 v[132:135], v1 offset:1024
  s_waitcnt lgkmcnt(4)
  v_mfma_f32_32x32x16_bf16 v[96:111], v[144:147], a[100:103], v[96:111]
  ds_read_b128 v[136:139], v1 offset:2048
  buffer_load_dwordx4 v[28:31], v1, s[8:11], s27 offen offset:3072 sc1
  v_mfma_f32_32x32x16_bf16 v[112:127], v[148:151], a[100:103], v[112:127]
  ds_read_b128 v[140:143], v1 offset:3072
  s_waitcnt lgkmcnt(4)
  v_mfma_f32_32x32x16_bf16 v[80:95], v[152:155], a[104:107], v[80:95]
  ds_read_b128 v[144:147], v1 offset:4096
  s_add_u32 s27, s52, 60416
  buffer_load_dwordx4 v[32:35], v1, s[8:11], s27 offen offset:0 sc1
  v_mfma_f32_32x32x16_bf16 v[96:111], v[156:159], a[104:107], v[96:111]
  ds_read_b128 v[148:151], v1 offset:5120
  s_waitcnt lgkmcnt(4)
  v_mfma_f32_32x32x16_bf16 v[112:127], v[128:131], a[104:107], v[112:127]
  ds_read_b128 v[152:155], v1 offset:6144
  s_add_u32 s27, s52, 46080
  buffer_load_dwordx4 a[80:83], v1, s[8:11], s27 offen offset:0 sc1
  v_mfma_f32_32x32x16_bf16 v[80:95], v[132:135], a[108:111], v[80:95]
  ds_read_b128 v[156:159], v1 offset:7168
  s_waitcnt lgkmcnt(4)
  v_mfma_f32_32x32x16_bf16 v[96:111], v[136:139], a[108:111], v[96:111]
  ds_read_b128 v[128:131], v1 offset:8192
  buffer_load_dwordx4 a[84:87], v1, s[8:11], s27 offen offset:1024 sc1
  v_mfma_f32_32x32x16_bf16 v[112:127], v[140:143], a[108:111], v[112:127]
  ds_read_b128 v[132:135], v1 offset:9216
  s_waitcnt lgkmcnt(4)
  v_mfma_f32_32x32x16_bf16 v[80:95], v[144:147], a[112:115], v[80:95]
  ds_read_b128 v[136:139], v1 offset:10240
  buffer_load_dwordx4 a[88:91], v1, s[8:11], s27 offen offset:2048 sc1
  v_mfma_f32_32x32x16_bf16 v[96:111], v[148:151], a[112:115], v[96:111]
  ds_read_b128 v[140:143], v1 offset:11264
  s_waitcnt lgkmcnt(4)
  v_mfma_f32_32x32x16_bf16 v[112:127], v[152:155], a[112:115], v[112:127]
  ds_read_b128 v[144:147], v1 offset:12288
  buffer_load_dwordx4 a[92:95], v1, s[8:11], s27 offen offset:3072 sc1
  v_mfma_f32_32x32x16_bf16 v[80:95], v[156:159], a[116:119], v[80:95]
  ds_read_b128 v[148:151], v1 offset:13312
  s_waitcnt lgkmcnt(4)
  v_mfma_f32_32x32x16_bf16 v[96:111], v[128:131], a[116:119], v[96:111]
  ds_read_b128 v[152:155], v1 offset:14336
  s_add_u32 s27, s52, 50176
  buffer_load_dwordx4 a[96:99], v1, s[8:11], s27 offen offset:0 sc1
  v_mfma_f32_32x32x16_bf16 v[112:127], v[132:135], a[116:119], v[112:127]
  ds_read_b128 v[156:159], v1 offset:15360
  s_waitcnt lgkmcnt(4)
  v_mfma_f32_32x32x16_bf16 v[80:95], v[136:139], a[120:123], v[80:95]
  ds_read_b128 v[128:131], v1 offset:16384
  s_add_u32 s27, s52, 51200
  buffer_load_dwordx4 a[100:103], v1, s[8:11], s27 offen offset:0 sc1
  v_mfma_f32_32x32x16_bf16 v[96:111], v[140:143], a[120:123], v[96:111]
  ds_read_b128 v[132:135], v1 offset:17408
  s_waitcnt lgkmcnt(4)
  v_mfma_f32_32x32x16_bf16 v[112:127], v[144:147], a[120:123], v[112:127]
  ds_read_b128 v[136:139], v1 offset:18432
  buffer_load_dwordx4 a[104:107], v1, s[8:11], s27 offen offset:1024 sc1
  s_mul_i32 s30, s19, 917504
  s_lshl_b32 s31, s16, 13
  s_add_u32 s30, s30, s31
  s_add_u32 s30, s30, 786432
  s_add_u32 s30, s30, s22
  v_mov_b32 v14, s25
  s_waitcnt vmcnt(13)
  s_mov_b64 exec, 1
  buffer_store_dword v14, v4, s[8:11], s30 offen sc1
  s_mov_b64 exec, -1
  v_mfma_f32_32x32x16_bf16 v[80:95], v[148:151], a[124:127], v[80:95]
  ds_read_b128 v[140:143], v1 offset:19456
  s_waitcnt lgkmcnt(4)
  v_mfma_f32_32x32x16_bf16 v[96:111], v[152:155], a[124:127], v[96:111]
  s_barrier
  ds_read_b128 v[144:147], v1 offset:20480
  buffer_load_dwordx4 a[108:111], v1, s[8:11], s27 offen offset:2048 sc1
  v_mfma_f32_32x32x16_bf16 v[112:127], v[156:159], a[124:127], v[112:127]
  ds_read_b128 v[148:151], v1 offset:21504
  s_waitcnt lgkmcnt(4)
  v_mfma_f32_32x32x16_bf16 v[80:95], v[128:131], a[128:131], v[80:95]
  ds_read_b128 v[152:155], v1 offset:22528
  buffer_load_dwordx4 a[112:115], v1, s[8:11], s27 offen offset:3072 sc1
  v_mfma_f32_32x32x16_bf16 v[96:111], v[132:135], a[128:131], v[96:111]
  ds_read_b128 v[156:159], v1 offset:23552
  s_waitcnt lgkmcnt(4)
  v_mfma_f32_32x32x16_bf16 v[112:127], v[136:139], a[128:131], v[112:127]
  ds_read_b128 v[128:131], v1 offset:24576
  s_add_u32 s27, s52, 55296
  buffer_load_dwordx4 a[116:119], v1, s[8:11], s27 offen offset:0 sc1
  v_mfma_f32_32x32x16_bf16 v[80:95], v[140:143], a[132:135], v[80:95]
  ds_read_b128 v[132:135], v1 offset:25600
  s_waitcnt lgkmcnt(4)
  v_mfma_f32_32x32x16_bf16 v[96:111], v[144:147], a[132:135], v[96:111]
  ds_read_b128 v[136:139], v1 offset:26624
  v_mfma_f32_32x32x16_bf16 v[112:127], v[148:151], a[132:135], v[112:127]
  ds_read_b128 v[140:143], v1 offset:27648
  s_waitcnt lgkmcnt(4)
  v_mfma_f32_32x32x16_bf16 v[80:95], v[152:155], a[136:139], v[80:95]
  ds_read_b128 v[144:147], v1 offset:28672
  v_mfma_f32_32x32x16_bf16 v[96:111], v[156:159], a[136:139], v[96:111]
  ds_read_b128 v[148:151], v1 offset:29696
  s_waitcnt lgkmcnt(4)
  v_mfma_f32_32x32x16_bf16 v[112:127], v[128:131], a[136:139], v[112:127]
  ds_read_b128 v[152:155], v1 offset:30720
  v_mfma_f32_32x32x16_bf16 v[80:95], v[132:135], a[140:143], v[80:95]
  ds_read_b128 v[156:159], v1 offset:31744
  s_waitcnt lgkmcnt(4)
  v_mfma_f32_32x32x16_bf16 v[96:111], v[136:139], a[140:143], v[96:111]
  ds_read_b128 v[128:131], v1 offset:32768
  v_mfma_f32_32x32x16_bf16 v[112:127], v[140:143], a[140:143], v[112:127]
  ds_read_b128 v[132:135], v1 offset:33792
  s_waitcnt lgkmcnt(4)
  v_mfma_f32_32x32x16_bf16 v[80:95], v[144:147], a[144:147], v[80:95]
  ds_read_b128 v[136:139], v1 offset:34816
  v_mfma_f32_32x32x16_bf16 v[96:111], v[148:151], a[144:147], v[96:111]
  ds_read_b128 v[140:143], v1 offset:35840
  s_waitcnt lgkmcnt(4)
  v_mfma_f32_32x32x16_bf16 v[112:127], v[152:155], a[144:147], v[112:127]
  ds_read_b128 v[144:147], v1 offset:36864
  s_mul_i32 s24, s19, 917504
  s_lshl_b32 s31, s16, 13
  s_add_u32 s24, s24, s31
  s_add_u32 s24, s24, 786432
  s_lshl_b32 s31, s21, 8
  s_add_u32 s24, s24, s31
  s_lshl_b32 s31, s18, 11
  s_add_u32 s24, s24, s31
  v_and_b32 v225, 3, v5
  v_lshlrev_b32 v225, 9, v225
  v_bfe_u32 v224, v5, 2, 1
  v_lshl_add_u32 v225, v224, 7, v225
  v_mov_b32 v224, s25
  s_mov_b64 exec, 0xff
  buffer_load_dword v224, v225, s[8:11], s24 offen sc1
  s_mov_b64 exec, -1
  v_mfma_f32_32x32x16_bf16 v[80:95], v[156:159], a[148:151], v[80:95]
  ds_read_b128 v[148:151], v1 offset:37888
  s_waitcnt lgkmcnt(4)
  v_mfma_f32_32x32x16_bf16 v[96:111], v[128:131], a[148:151], v[96:111]
  ds_read_b128 v[152:155], v1 offset:38912
  v_mfma_f32_32x32x16_bf16 v[112:127], v[132:135], a[148:151], v[112:127]
  ds_read_b128 v[156:159], v1 offset:39936
  s_waitcnt lgkmcnt(4)
  v_mfma_f32_32x32x16_bf16 v[80:95], v[136:139], a[152:155], v[80:95]
  v_mfma_f32_32x32x16_bf16 v[96:111], v[140:143], a[152:155], v[96:111]
  s_waitcnt lgkmcnt(2)
  v_mfma_f32_32x32x16_bf16 v[112:127], v[144:147], a[152:155], v[112:127]
  v_mfma_f32_32x32x16_bf16 v[80:95], v[148:151], a[156:159], v[80:95]
  s_waitcnt lgkmcnt(0)
  v_mfma_f32_32x32x16_bf16 v[96:111], v[152:155], a[156:159], v[96:111]
  v_mfma_f32_32x32x16_bf16 v[112:127], v[156:159], a[156:159], v[112:127]
  v_mfma_f32_32x32x8_bf16 v[80:95], v[184:185], v[230:231], v[80:95]
  v_mfma_f32_32x32x8_bf16 v[96:111], v[186:187], v[230:231], v[96:111]
  v_mfma_f32_32x32x8_bf16 v[112:127], v[188:189], v[230:231], v[112:127]
  s_barrier
  s_waitcnt vmcnt(0)
  v_cmp_ne_u32 vcc, s25, v224
  s_cbranch_vccz PL_8_k
  s_mov_b32 s32, 0x40000
  s_mov_b64 exec, 0xff
PL_8_p:
  buffer_load_dword v224, v225, s[8:11], s24 offen sc1
  s_sub_u32 s32, s32, 1
  s_cbranch_scc1 PL_8_d
  s_waitcnt vmcnt(0)
  v_cmp_ne_u32 vcc, s25, v224
  s_cbranch_vccnz PL_8_p
PL_8_d:
  s_mov_b64 exec, -1
PL_8_k:
  s_mul_i32 s54, s17, 163840
  s_mul_i32 s55, s18, 25600
  s_add_u32 s54, s54, s55
  s_lshl_b32 s31, s19, 30
  s_add_u32 s54, s54, s31
  buffer_load_dwordx4 a[120:123], v1, s[8:11], s44 offen offset:0 sc1
  v_pk_mul_f32 v[160:161], v[80:81], v[232:233] op_sel:[0,1] op_sel_hi:[1,1]
  v_pk_mul_f32 v[80:81], v[80:81], v[88:89]
  v_pk_mul_f32 v[162:163], v[82:83], v[232:233] op_sel:[0,1] op_sel_hi:[1,1]
  v_pk_mul_f32 v[82:83], v[82:83], v[90:91]
  v_pk_mul_f32 v[164:165], v[84:85], v[232:233] op_sel:[0,1] op_sel_hi:[1,1]
  v_pk_mul_f32 v[84:85], v[84:85], v[92:93]
  v_pk_mul_f32 v[166:167], v[86:87], v[232:233] op_sel:[0,1] op_sel_hi:[1,1]
  v_pk_mul_f32 v[86:87], v[86:87], v[94:95]
  buffer_load_dwordx4 a[124:127], v1, s[8:11], s45 offen offset:0 sc1
  v_exp_f32 v160, v160
  v_exp_f32 v161, v161
  v_exp_f32 v162, v162
  v_exp_f32 v163, v163
  v_exp_f32 v164, v164
  v_exp_f32 v165, v165
  v_exp_f32 v166, v166
  v_exp_f32 v167, v167
  buffer_load_dwordx4 a[128:131], v1, s[8:11], s46 offen offset:0 sc1
  v_pk_fma_f32 v[160:161], v[160:161], v[232:233], v[232:233] op_sel_hi:[1,0,0]
  v_pk_fma_f32 v[162:163], v[162:163], v[232:233], v[232:233] op_sel_hi:[1,0,0]
  v_pk_fma_f32 v[164:165], v[164:165], v[232:233], v[232:233] op_sel_hi:[1,0,0]
  v_pk_fma_f32 v[166:167], v[166:167], v[232:233], v[232:233] op_sel_hi:[1,0,0]
  buffer_load_dwordx4 a[132:135], v1, s[8:11], s47 offen offset:0 sc1
  v_rcp_f32 v160, v160
  v_rcp_f32 v161, v161
  v_rcp_f32 v162, v162
  v_rcp_f32 v163, v163
  v_rcp_f32 v164, v164
  v_rcp_f32 v165, v165
  v_rcp_f32 v166, v166
  v_rcp_f32 v167, v167
  buffer_load_dwordx4 a[136:139], v1, s[8:11], s44 offen offset:1024 sc1
  v_pk_mul_f32 v[80:81], v[80:81], v[160:161]
  v_pk_mul_f32 v[82:83], v[82:83], v[162:163]
  v_pk_mul_f32 v[84:85], v[84:85], v[164:165]
  v_pk_mul_f32 v[86:87], v[86:87], v[166:167]
  v_cvt_pk_bf16_f32 v88, v80, v81
  v_cvt_pk_bf16_f32 v89, v82, v83
  v_cvt_pk_bf16_f32 v90, v84, v85
  v_cvt_pk_bf16_f32 v91, v86, v87
  buffer_store_dwordx4 v[88:91], v9, s[8:11], s51 offen offset:0 sc1
  buffer_load_dwordx4 a[140:143], v1, s[8:11], s45 offen offset:1024 sc1
  v_pk_mul_f32 v[160:161], v[96:97], v[232:233] op_sel:[0,1] op_sel_hi:[1,1]
  v_pk_mul_f32 v[96:97], v[96:97], v[104:105]
  v_pk_mul_f32 v[162:163], v[98:99], v[232:233] op_sel:[0,1] op_sel_hi:[1,1]
  v_pk_mul_f32 v[98:99], v[98:99], v[106:107]
  v_pk_mul_f32 v[164:165], v[100:101], v[232:233] op_sel:[0,1] op_sel_hi:[1,1]
  v_pk_mul_f32 v[100:101], v[100:101], v[108:109]
  v_pk_mul_f32 v[166:167], v[102:103], v[232:233] op_sel:[0,1] op_sel_hi:[1,1]
  v_pk_mul_f32 v[102:103], v[102:103], v[110:111]
  buffer_load_dwordx4 a[144:147], v1, s[8:11], s46 offen offset:1024 sc1
  v_exp_f32 v160, v160
  v_exp_f32 v161, v161
  v_exp_f32 v162, v162
  v_exp_f32 v163, v163
  v_exp_f32 v164, v164
  v_exp_f32 v165, v165
  v_exp_f32 v166, v166
  v_exp_f32 v167, v167
  buffer_load_dwordx4 a[148:151], v1, s[8:11], s47 offen offset:1024 sc1
  v_pk_fma_f32 v[160:161], v[160:161], v[232:233], v[232:233] op_sel_hi:[1,0,0]
  v_pk_fma_f32 v[162:163], v[162:163], v[232:233], v[232:233] op_sel_hi:[1,0,0]
  v_pk_fma_f32 v[164:165], v[164:165], v[232:233], v[232:233] op_sel_hi:[1,0,0]
  v_pk_fma_f32 v[166:167], v[166:167], v[232:233], v[232:233] op_sel_hi:[1,0,0]
  buffer_load_dwordx4 a[152:155], v1, s[8:11], s44 offen offset:2048 sc1
  v_rcp_f32 v160, v160
  v_rcp_f32 v161, v161
  v_rcp_f32 v162, v162
  v_rcp_f32 v163, v163
  v_rcp_f32 v164, v164
  v_rcp_f32 v165, v165
  v_rcp_f32 v166, v166
  v_rcp_f32 v167, v167
  buffer_load_dwordx4 a[156:159], v1, s[8:11], s45 offen offset:2048 sc1
  v_pk_mul_f32 v[96:97], v[96:97], v[160:161]
  v_pk_mul_f32 v[98:99], v[98:99], v[162:163]
  v_pk_mul_f32 v[100:101], v[100:101], v[164:165]
  v_pk_mul_f32 v[102:103], v[102:103], v[166:167]
  v_cvt_pk_bf16_f32 v104, v96, v97
  v_cvt_pk_bf16_f32 v105, v98, v99
  v_cvt_pk_bf16_f32 v106, v100, v101
  v_cvt_pk_bf16_f32 v107, v102, v103
  buffer_store_dwordx4 v[104:107], v9, s[8:11], s51 offen offset:512 sc1
  buffer_load_dwordx4 a[240:243], v1, s[8:11], s46 offen offset:2048 sc1
  v_pk_mul_f32 v[160:161], v[112:113], v[232:233] op_sel:[0,1] op_sel_hi:[1,1]
  v_pk_mul_f32 v[112:113], v[112:113], v[120:121]
  v_pk_mul_f32 v[162:163], v[114:115], v[232:233] op_sel:[0,1] op_sel_hi:[1,1]
  v_pk_mul_f32 v[114:115], v[114:115], v[122:123]
  v_pk_mul_f32 v[164:165], v[116:117], v[232:233] op_sel:[0,1] op_sel_hi:[1,1]
  v_pk_mul_f32 v[116:117], v[116:117], v[124:125]
  v_pk_mul_f32 v[166:167], v[118:119], v[232:233] op_sel:[0,1] op_sel_hi:[1,1]
  v_pk_mul_f32 v[118:119], v[118:119], v[126:127]
  buffer_load_dwordx4 a[244:247], v1, s[8:11], s47 offen offset:2048 sc1
  v_exp_f32 v160, v160
  v_exp_f32 v161, v161
  v_exp_f32 v162, v162
  v_exp_f32 v163, v163
  v_exp_f32 v164, v164
  v_exp_f32 v165, v165
  v_exp_f32 v166, v166
  v_exp_f32 v167, v167
  buffer_load_dwordx4 a[248:251], v1, s[8:11], s44 offen offset:3072 sc1
  v_pk_fma_f32 v[160:161], v[160:161], v[232:233], v[232:233] op_sel_hi:[1,0,0]
  v_pk_fma_f32 v[162:163], v[162:163], v[232:233], v[232:233] op_sel_hi:[1,0,0]
  v_pk_fma_f32 v[164:165], v[164:165], v[232:233], v[232:233] op_sel_hi:[1,0,0]
  v_pk_fma_f32 v[166:167], v[166:167], v[232:233], v[232:233] op_sel_hi:[1,0,0]
  buffer_load_dwordx4 a[252:255], v1, s[8:11], s45 offen offset:3072 sc1
  v_rcp_f32 v160, v160
  v_rcp_f32 v161, v161
  v_rcp_f32 v162, v162
  v_rcp_f32 v163, v163
  v_rcp_f32 v164, v164
  v_rcp_f32 v165, v165
  v_rcp_f32 v166, v166
  v_rcp_f32 v167, v167
  buffer_load_dwordx4 v[212:215], v1, s[8:11], s46 offen offset:3072 sc1
  v_pk_mul_f32 v[112:113], v[112:113], v[160:161]
  v_pk_mul_f32 v[114:115], v[114:115], v[162:163]
  v_pk_mul_f32 v[116:117], v[116:117], v[164:165]
  v_pk_mul_f32 v[118:119], v[118:119], v[166:167]
  v_cvt_pk_bf16_f32 v120, v112, v113
  v_cvt_pk_bf16_f32 v121, v114, v115
  v_cvt_pk_bf16_f32 v122, v116, v117
  v_cvt_pk_bf16_f32 v123, v118, v119
  s_cmp_ge_u32 s17, 12
  s_cselect_b32 s51, 0x7fff0000, s51
  buffer_store_dwordx4 v[120:123], v9, s[8:11], s51 offen offset:1024 sc1
  s_waitcnt vmcnt(17)
  v_mfma_f32_16x16x32_bf16 v[80:83], a[160:163], a[120:123], 0
  buffer_load_dwordx4 v[216:219], v1, s[8:11], s47 offen offset:3072 sc1
  v_mfma_f32_16x16x32_bf16 v[84:87], a[164:167], a[120:123], 0
  v_mfma_f32_16x16x32_bf16 v[88:91], a[168:171], a[120:123], 0
  v_mfma_f32_16x16x32_bf16 v[92:95], a[172:175], a[120:123], 0
  v_mfma_f32_16x16x32_bf16 v[96:99], a[176:179], a[120:123], 0
  s_add_u32 s44, s44, 4096
  buffer_load_dwordx4 v[220:223], v1, s[8:11], s44 offen offset:0 sc1
  s_waitcnt vmcnt(18)
  v_mfma_f32_16x16x32_bf16 v[100:103], a[160:163], a[124:127], 0
  v_mfma_f32_16x16x32_bf16 v[104:107], a[164:167], a[124:127], 0
  v_mfma_f32_16x16x32_bf16 v[108:111], a[168:171], a[124:127], 0
  v_mfma_f32_16x16x32_bf16 v[112:115], a[172:175], a[124:127], 0
  s_add_u32 s45, s45, 4096
  buffer_load_dwordx4 v[76:79], v1, s[8:11], s45 offen offset:0 sc1
  v_mfma_f32_16x16x32_bf16 v[116:119], a[176:179], a[124:127], 0
  s_waitcnt vmcnt(18)
  v_mfma_f32_16x16x32_bf16 v[120:123], a[160:163], a[128:131], 0
  v_mfma_f32_16x16x32_bf16 v[124:127], a[164:167], a[128:131], 0
  v_mfma_f32_16x16x32_bf16 v[128:131], a[168:171], a[128:131], 0
  s_add_u32 s46, s46, 4096
  buffer_load_dwordx4 v[168:171], v1, s[8:11], s46 offen offset:0 sc1
  v_mfma_f32_16x16x32_bf16 v[132:135], a[172:175], a[128:131], 0
  v_mfma_f32_16x16x32_bf16 v[136:139], a[176:179], a[128:131], 0
  s_waitcnt vmcnt(18)
  v_mfma_f32_16x16x32_bf16 v[140:143], a[160:163], a[132:135], 0
  v_mfma_f32_16x16x32_bf16 v[144:147], a[164:167], a[132:135], 0
  s_add_u32 s47, s47, 4096
  buffer_load_dwordx4 v[172:175], v1, s[8:11], s47 offen offset:0 sc1
  v_mfma_f32_16x16x32_bf16 v[148:151], a[168:171], a[132:135], 0
  v_mfma_f32_16x16x32_bf16 v[152:155], a[172:175], a[132:135], 0
  v_mfma_f32_16x16x32_bf16 v[156:159], a[176:179], a[132:135], 0
  s_waitcnt vmcnt(18)
  v_mfma_f32_16x16x32_bf16 v[80:83], a[180:183], a[136:139], v[80:83]
  buffer_load_dwordx4 v[176:179], v1, s[8:11], s44 offen offset:1024 sc1
  v_mfma_f32_16x16x32_bf16 v[84:87], a[184:187], a[136:139], v[84:87]
  v_mfma_f32_16x16x32_bf16 v[88:91], a[188:191], a[136:139], v[88:91]
  v_mfma_f32_16x16x32_bf16 v[92:95], a[192:195], a[136:139], v[92:95]
  v_mfma_f32_16x16x32_bf16 v[96:99], a[196:199], a[136:139], v[96:99]
  buffer_load_dwordx4 v[180:183], v1, s[8:11], s45 offen offset:1024 sc1
  s_waitcnt vmcnt(18)
  v_mfma_f32_16x16x32_bf16 v[100:103], a[180:183], a[140:143], v[100:103]
  v_mfma_f32_16x16x32_bf16 v[104:107], a[184:187], a[140:143], v[104:107]
  v_mfma_f32_16x16x32_bf16 v[108:111], a[188:191], a[140:143], v[108:111]
  v_mfma_f32_16x16x32_bf16 v[112:115], a[192:195], a[140:143], v[112:115]
  buffer_load_dwordx4 v[184:187], v1, s[8:11], s46 offen offset:1024 sc1
  v_mfma_f32_16x16x32_bf16 v[116:119], a[196:199], a[140:143], v[116:119]
  s_waitcnt vmcnt(18)
  v_mfma_f32_16x16x32_bf16 v[120:123], a[180:183], a[144:147], v[120:123]
  v_mfma_f32_16x16x32_bf16 v[124:127], a[184:187], a[144:147], v[124:127]
  v_mfma_f32_16x16x32_bf16 v[128:131], a[188:191], a[144:147], v[128:131]
  buffer_load_dwordx4 v[188:191], v1, s[8:11], s47 offen offset:1024 sc1
  v_mfma_f32_16x16x32_bf16 v[132:135], a[192:195], a[144:147], v[132:135]
  v_mfma_f32_16x16x32_bf16 v[136:139], a[196:199], a[144:147], v[136:139]
  s_waitcnt vmcnt(18)
  v_mfma_f32_16x16x32_bf16 v[140:143], a[180:183], a[148:151], v[140:143]
  v_mfma_f32_16x16x32_bf16 v[144:147], a[184:187], a[148:151], v[144:147]
  buffer_load_dwordx4 v[160:163], v1, s[8:11], s44 offen offset:2048 sc1
  v_mfma_f32_16x16x32_bf16 v[148:151], a[188:191], a[148:151], v[148:151]
  v_mfma_f32_16x16x32_bf16 v[152:155], a[192:195], a[148:151], v[152:155]
  v_mfma_f32_16x16x32_bf16 v[156:159], a[196:199], a[148:151], v[156:159]
  s_mul_i32 s30, s19, 917504
  s_lshl_b32 s31, s16, 13
  s_add_u32 s30, s30, s31
  s_add_u32 s30, s30, 262144
  s_add_u32 s30, s30, s22
  v_mov_b32 v14, s25
  s_waitcnt vmcnt(10)
  s_mov_b64 exec, 1
  buffer_store_dword v14, v4, s[8:11], s30 offen sc1
  s_mov_b64 exec, -1
  v_mfma_f32_16x16x32_bf16 v[80:83], a[200:203], a[152:155], v[80:83]
  buffer_load_dwordx4 v[164:167], v1, s[8:11], s45 offen offset:2048 sc1
  v_mfma_f32_16x16x32_bf16 v[84:87], a[204:207], a[152:155], v[84:87]
  v_mfma_f32_16x16x32_bf16 v[88:91], a[208:211], a[152:155], v[88:91]
  v_mfma_f32_16x16x32_bf16 v[92:95], a[212:215], a[152:155], v[92:95]
  v_mfma_f32_16x16x32_bf16 v[96:99], a[216:219], a[152:155], v[96:99]
  buffer_load_dwordx4 a[120:123], v1, s[8:11], s46 offen offset:2048 sc1
  v_mfma_f32_16x16x32_bf16 v[100:103], a[200:203], a[156:159], v[100:103]
  v_mfma_f32_16x16x32_bf16 v[104:107], a[204:207], a[156:159], v[104:107]
  v_mfma_f32_16x16x32_bf16 v[108:111], a[208:211], a[156:159], v[108:111]
  v_mfma_f32_16x16x32_bf16 v[112:115], a[212:215], a[156:159], v[112:115]
  buffer_load_dwordx4 a[124:127], v1, s[8:11], s47 offen offset:2048 sc1
  v_mfma_f32_16x16x32_bf16 v[116:119], a[216:219], a[156:159], v[116:119]
  v_mfma_f32_16x16x32_bf16 v[120:123], a[200:203], a[240:243], v[120:123]
  v_mfma_f32_16x16x32_bf16 v[124:127], a[204:207], a[240:243], v[124:127]
  v_mfma_f32_16x16x32_bf16 v[128:131], a[208:211], a[240:243], v[128:131]
  buffer_load_dwordx4 a[128:131], v1, s[8:11], s44 offen offset:3072 sc1
  v_mfma_f32_16x16x32_bf16 v[132:135], a[212:215], a[240:243], v[132:135]
  v_mfma_f32_16x16x32_bf16 v[136:139], a[216:219], a[240:243], v[136:139]
  v_mfma_f32_16x16x32_bf16 v[140:143], a[200:203], a[244:247], v[140:143]
  v_mfma_f32_16x16x32_bf16 v[144:147], a[204:207], a[244:247], v[144:147]
  buffer_load_dwordx4 a[132:135], v1, s[8:11], s45 offen offset:3072 sc1
  v_mfma_f32_16x16x32_bf16 v[148:151], a[208:211], a[244:247], v[148:151]
  v_mfma_f32_16x16x32_bf16 v[152:155], a[212:215], a[244:247], v[152:155]
  v_mfma_f32_16x16x32_bf16 v[156:159], a[216:219], a[244:247], v[156:159]
  v_mfma_f32_16x16x32_bf16 v[80:83], a[220:223], a[248:251], v[80:83]
  buffer_load_dwordx4 a[160:163], v1, s[8:11], s46 offen offset:3072 sc1
  v_mfma_f32_16x16x32_bf16 v[84:87], a[224:227], a[248:251], v[84:87]
  v_mfma_f32_16x16x32_bf16 v[88:91], a[228:231], a[248:251], v[88:91]
  v_mfma_f32_16x16x32_bf16 v[92:95], a[232:235], a[248:251], v[92:95]
  v_mfma_f32_16x16x32_bf16 v[96:99], a[236:239], a[248:251], v[96:99]
  buffer_load_dwordx4 a[164:167], v1, s[8:11], s47 offen offset:3072 sc1
  v_mfma_f32_16x16x32_bf16 v[100:103], a[220:223], a[252:255], v[100:103]
  v_mfma_f32_16x16x32_bf16 v[104:107], a[224:227], a[252:255], v[104:107]
  v_mfma_f32_16x16x32_bf16 v[108:111], a[228:231], a[252:255], v[108:111]
  v_mfma_f32_16x16x32_bf16 v[112:115], a[232:235], a[252:255], v[112:115]
  s_add_u32 s27, s52, 61440
  s_add_u32 s27, s27, s53
  buffer_load_dwordx4 v[36:39], v1, s[8:11], s27 offen offset:0 sc1
  v_mfma_f32_16x16x32_bf16 v[116:119], a[236:239], a[252:255], v[116:119]
  v_mfma_f32_16x16x32_bf16 v[120:123], a[220:223], v[212:215], v[120:123]
  v_mfma_f32_16x16x32_bf16 v[124:127], a[224:227], v[212:215], v[124:127]
  v_mfma_f32_16x16x32_bf16 v[128:131], a[228:231], v[212:215], v[128:131]
  buffer_load_dwordx4 v[40:43], v1, s[8:11], s27 offen offset:1024 sc1
  v_mfma_f32_16x16x32_bf16 v[132:135], a[232:235], v[212:215], v[132:135]
  v_mfma_f32_16x16x32_bf16 v[136:139], a[236:239], v[212:215], v[136:139]
  s_waitcnt vmcnt(19)
  v_mfma_f32_16x16x32_bf16 v[140:143], a[220:223], v[216:219], v[140:143]
  v_mfma_f32_16x16x32_bf16 v[144:147], a[224:227], v[216:219], v[144:147]
  buffer_load_dwordx4 v[44:47], v1, s[8:11], s27 offen offset:2048 sc1
  v_mfma_f32_16x16x32_bf16 v[148:151], a[228:231], v[216:219], v[148:151]
  v_mfma_f32_16x16x32_bf16 v[152:155], a[232:235], v[216:219], v[152:155]
  v_mfma_f32_16x16x32_bf16 v[156:159], a[236:239], v[216:219], v[156:159]
  s_waitcnt vmcnt(19)
  v_mfma_f32_16x16x32_bf16 v[80:83], v[192:195], v[220:223], v[80:83]
  buffer_load_dwordx4 v[48:51], v1, s[8:11], s27 offen offset:3072 sc1
  v_mfma_f32_16x16x32_bf16 v[84:87], v[196:199], v[220:223], v[84:87]
  v_mfma_f32_16x16x32_bf16 v[88:91], v[200:203], v[220:223], v[88:91]
  v_mfma_f32_16x16x32_bf16 v[92:95], v[204:207], v[220:223], v[92:95]
  v_mfma_f32_16x16x32_bf16 v[96:99], v[208:211], v[220:223], v[96:99]
  s_add_u32 s27, s52, 65536
  s_add_u32 s27, s27, s53
  buffer_load_dwordx4 v[52:55], v1, s[8:11], s27 offen offset:0 sc1
  s_mul_i32 s24, s19, 917504
  s_lshl_b32 s31, s16, 13
  s_add_u32 s24, s24, s31
  s_add_u32 s24, s24, 262144
  s_lshl_b32 s31, s21, 8
  s_add_u32 s24, s24, s31
  s_lshl_b32 s31, s18, 11
  s_add_u32 s24, s24, s31
  v_and_b32 v225, 3, v5
  v_lshlrev_b32 v225, 9, v225
  v_bfe_u32 v224, v5, 2, 1
  v_lshl_add_u32 v225, v224, 7, v225
  v_mov_b32 v224, s25
  s_mov_b64 exec, 0xff
  buffer_load_dword v224, v225, s[8:11], s24 offen sc1
  s_mov_b64 exec, -1
  s_waitcnt vmcnt(21)
  v_mfma_f32_16x16x32_bf16 v[100:103], v[192:195], v[76:79], v[100:103]
  v_mfma_f32_16x16x32_bf16 v[104:107], v[196:199], v[76:79], v[104:107]
  v_mfma_f32_16x16x32_bf16 v[108:111], v[200:203], v[76:79], v[108:111]
  v_mfma_f32_16x16x32_bf16 v[112:115], v[204:207], v[76:79], v[112:115]
  s_add_u32 s27, s52, 66560
  s_add_u32 s27, s27, s53
  buffer_load_dwordx4 v[56:59], v1, s[8:11], s27 offen offset:0 sc1
  v_mfma_f32_16x16x32_bf16 v[116:119], v[208:211], v[76:79], v[116:119]
  s_waitcnt vmcnt(21)
  v_mfma_f32_16x16x32_bf16 v[120:123], v[192:195], v[168:171], v[120:123]
  v_mfma_f32_16x16x32_bf16 v[124:127], v[196:199], v[168:171], v[124:127]
  v_mfma_f32_16x16x32_bf16 v[128:131], v[200:203], v[168:171], v[128:131]
  buffer_load_dwordx4 v[60:63], v1, s[8:11], s27 offen offset:1024 sc1
  v_mfma_f32_16x16x32_bf16 v[132:135], v[204:207], v[168:171], v[132:135]
  v_mfma_f32_16x16x32_bf16 v[136:139], v[208:211], v[168:171], v[136:139]
  s_waitcnt vmcnt(21)
  v_mfma_f32_16x16x32_bf16 v[140:143], v[192:195], v[172:175], v[140:143]
  v_mfma_f32_16x16x32_bf16 v[144:147], v[196:199], v[172:175], v[144:147]
  buffer_load_dwordx4 v[64:67], v1, s[8:11], s27 offen offset:2048 sc1
  v_mfma_f32_16x16x32_bf16 v[148:151], v[200:203], v[172:175], v[148:151]
  v_mfma_f32_16x16x32_bf16 v[152:155], v[204:207], v[172:175], v[152:155]
  v_mfma_f32_16x16x32_bf16 v[156:159], v[208:211], v[172:175], v[156:159]
  s_waitcnt vmcnt(21)
  v_mfma_f32_16x16x32_bf16 v[80:83], a[0:3], v[176:179], v[80:83]
  buffer_load_dwordx4 v[68:71], v1, s[8:11], s27 offen offset:3072 sc1
  v_mfma_f32_16x16x32_bf16 v[84:87], a[4:7], v[176:179], v[84:87]
  v_mfma_f32_16x16x32_bf16 v[88:91], a[8:11], v[176:179], v[88:91]
  v_mfma_f32_16x16x32_bf16 v[92:95], a[12:15], v[176:179], v[92:95]
  v_mfma_f32_16x16x32_bf16 v[96:99], a[16:19], v[176:179], v[96:99]
  s_add_u32 s27, s52, 70656
  s_add_u32 s27, s27, s53
  buffer_load_dwordx4 v[72:75], v1, s[8:11], s27 offen offset:0 sc1
  s_waitcnt vmcnt(22)
  v_mfma_f32_16x16x32_bf16 v[100:103], a[0:3], v[180:183], v[100:103]
  v_mfma_f32_16x16x32_bf16 v[104:107], a[4:7], v[180:183], v[104:107]
  v_mfma_f32_16x16x32_bf16 v[108:111], a[8:11], v[180:183], v[108:111]
  v_mfma_f32_16x16x32_bf16 v[112:115], a[12:15], v[180:183], v[112:115]
  s_add_u32 s28, s54, 1835008
  s_add_u32 m0, s55, 0
  s_nop 0
  buffer_load_dwordx4 v1, s[8:11], s28 offen offset:0 sc1 lds
  v_mfma_f32_16x16x32_bf16 v[116:119], a[16:19], v[180:183], v[116:119]
  s_waitcnt vmcnt(22)
  v_mfma_f32_16x16x32_bf16 v[120:123], a[0:3], v[184:187], v[120:123]
  v_mfma_f32_16x16x32_bf16 v[124:127], a[4:7], v[184:187], v[124:127]
  v_mfma_f32_16x16x32_bf16 v[128:131], a[8:11], v[184:187], v[128:131]
  buffer_load_dwordx4 v1, s[8:11], s28 offen offset:1024 sc1 lds
  v_mfma_f32_16x16x32_bf16 v[132:135], a[12:15], v[184:187], v[132:135]
  v_mfma_f32_16x16x32_bf16 v[136:139], a[16:19], v[184:187], v[136:139]
  s_waitcnt vmcnt(7)
  v_cmp_ne_u32 vcc, s25, v224
  s_cbranch_vccz PL_9_k
  s_mov_b32 s32, 0x40000
  s_mov_b64 exec, 0xff
PL_9_p:
  buffer_load_dword v224, v225, s[8:11], s24 offen sc1
  s_sub_u32 s32, s32, 1
  s_cbranch_scc1 PL_9_d
  s_waitcnt vmcnt(0)
  v_cmp_ne_u32 vcc, s25, v224
  s_cbranch_vccnz PL_9_p
PL_9_d:
  s_mov_b64 exec, -1
PL_9_k:
  s_add_u32 s44, s44, 4096
  buffer_load_dwordx4 a[168:171], v1, s[8:11], s44 offen offset:0 sc1
  s_add_u32 s45, s45, 4096
  buffer_load_dwordx4 a[172:175], v1, s[8:11], s45 offen offset:0 sc1
  s_add_u32 s46, s46, 4096
  buffer_load_dwordx4 a[176:179], v1, s[8:11], s46 offen offset:0 sc1
  v_mfma_f32_16x16x32_bf16 v[140:143], a[0:3], v[188:191], v[140:143]
  v_mfma_f32_16x16x32_bf16 v[144:147], a[4:7], v[188:191], v[144:147]
  s_add_u32 s47, s47, 4096
  buffer_load_dwordx4 a[136:139], v1, s[8:11], s47 offen offset:0 sc1
  v_mfma_f32_16x16x32_bf16 v[148:151], a[8:11], v[188:191], v[148:151]
  v_mfma_f32_16x16x32_bf16 v[152:155], a[12:15], v[188:191], v[152:155]
  v_mfma_f32_16x16x32_bf16 v[156:159], a[16:19], v[188:191], v[156:159]
  v_mfma_f32_16x16x32_bf16 v[80:83], a[20:23], v[160:163], v[80:83]
  buffer_load_dwordx4 a[140:143], v1, s[8:11], s44 offen offset:1024 sc1
  v_mfma_f32_16x16x32_bf16 v[84:87], a[24:27], v[160:163], v[84:87]
  v_mfma_f32_16x16x32_bf16 v[88:91], a[28:31], v[160:163], v[88:91]
  v_mfma_f32_16x16x32_bf16 v[92:95], a[32:35], v[160:163], v[92:95]
  v_mfma_f32_16x16x32_bf16 v[96:99], a[36:39], v[160:163], v[96:99]
  buffer_load_dwordx4 a[144:147], v1, s[8:11], s45 offen offset:1024 sc1
  v_mfma_f32_16x16x32_bf16 v[100:103], a[20:23], v[164:167], v[100:103]
  v_mfma_f32_16x16x32_bf16 v[104:107], a[24:27], v[164:167], v[104:107]
  v_mfma_f32_16x16x32_bf16 v[108:111], a[28:31], v[164:167], v[108:111]
  v_mfma_f32_16x16x32_bf16 v[112:115], a[32:35], v[164:167], v[112:115]
  buffer_load_dwordx4 a[148:151], v1, s[8:11], s46 offen offset:1024 sc1
  v_mfma_f32_16x16x32_bf16 v[116:119], a[36:39], v[164:167], v[116:119]
  v_mfma_f32_16x16x32_bf16 v[120:123], a[20:23], a[120:123], v[120:123]
  v_mfma_f32_16x16x32_bf16 v[124:127], a[24:27], a[120:123], v[124:127]
  v_mfma_f32_16x16x32_bf16 v[128:131], a[28:31], a[120:123], v[128:131]
  buffer_load_dwordx4 a[180:183], v1, s[8:11], s47 offen offset:1024 sc1
  v_mfma_f32_16x16x32_bf16 v[132:135], a[32:35], a[120:123], v[132:135]
  v_mfma_f32_16x16x32_bf16 v[136:139], a[36:39], a[120:123], v[136:139]
  v_mfma_f32_16x16x32_bf16 v[140:143], a[20:23], a[124:127], v[140:143]
  v_mfma_f32_16x16x32_bf16 v[144:147], a[24:27], a[124:127], v[144:147]
  buffer_load_dwordx4 a[184:187], v1, s[8:11], s44 offen offset:2048 sc1
  v_mfma_f32_16x16x32_bf16 v[148:151], a[28:31], a[124:127], v[148:151]
  v_mfma_f32_16x16x32_bf16 v[152:155], a[32:35], a[124:127], v[152:155]
  v_mfma_f32_16x16x32_bf16 v[156:159], a[36:39], a[124:127], v[156:159]
  v_mfma_f32_16x16x32_bf16 v[80:83], a[40:43], a[128:131], v[80:83]
  buffer_load_dwordx4 a[188:191], v1, s[8:11], s44 offen offset:3072 sc1
  v_mfma_f32_16x16x32_bf16 v[84:87], a[44:47], a[128:131], v[84:87]
  v_mfma_f32_16x16x32_bf16 v[88:91], a[48:51], a[128:131], v[88:91]
  v_mfma_f32_16x16x32_bf16 v[92:95], a[52:55], a[128:131], v[92:95]
  v_mfma_f32_16x16x32_bf16 v[96:99], a[56:59], a[128:131], v[96:99]
  s_add_u32 s44, s44, 4096
  s_add_u32 s44, s44, s53
  buffer_load_dwordx4 a[192:195], v1, s[8:11], s44 offen offset:0 sc1
  v_mfma_f32_16x16x32_bf16 v[100:103], a[40:43], a[132:135], v[100:103]
  v_mfma_f32_16x16x32_bf16 v[104:107], a[44:47], a[132:135], v[104:107]
  v_mfma_f32_16x16x32_bf16 v[108:111], a[48:51], a[132:135], v[108:111]
  v_mfma_f32_16x16x32_bf16 v[112:115], a[52:55], a[132:135], v[112:115]
  buffer_load_dwordx4 a[196:199], v1, s[8:11], s44 offen offset:1024 sc1
  v_mfma_f32_16x16x32_bf16 v[116:119], a[56:59], a[132:135], v[116:119]
  v_mfma_f32_16x16x32_bf16 v[120:123], a[40:43], a[160:163], v[120:123]
  v_mfma_f32_16x16x32_bf16 v[124:127], a[44:47], a[160:163], v[124:127]
  v_mfma_f32_16x16x32_bf16 v[128:131], a[48:51], a[160:163], v[128:131]
  buffer_load_dwordx4 a[152:155], v1, s[8:11], s45 offen offset:2048 sc1
  v_mfma_f32_16x16x32_bf16 v[132:135], a[52:55], a[160:163], v[132:135]
  v_mfma_f32_16x16x32_bf16 v[136:139], a[56:59], a[160:163], v[136:139]
  v_mfma_f32_16x16x32_bf16 v[140:143], a[40:43], a[164:167], v[140:143]
  v_mfma_f32_16x16x32_bf16 v[144:147], a[44:47], a[164:167], v[144:147]
  buffer_load_dwordx4 a[156:159], v1, s[8:11], s45 offen offset:3072 sc1
  v_mfma_f32_16x16x32_bf16 v[148:151], a[48:51], a[164:167], v[148:151]
  v_mfma_f32_16x16x32_bf16 v[152:155], a[52:55], a[164:167], v[152:155]
  v_mfma_f32_16x16x32_bf16 v[156:159], a[56:59], a[164:167], v[156:159]
  s_waitcnt vmcnt(13)
  v_mfma_f32_16x16x32_bf16 v[80:83], a[60:63], a[168:171], v[80:83]
  s_add_u32 s45, s45, 4096
  s_add_u32 s45, s45, s53
  buffer_load_dwordx4 a[240:243], v1, s[8:11], s45 offen offset:0 sc1
  v_mfma_f32_16x16x32_bf16 v[84:87], a[64:67], a[168:171], v[84:87]
  v_mfma_f32_16x16x32_bf16 v[88:91], a[68:71], a[168:171], v[88:91]
  v_mfma_f32_16x16x32_bf16 v[92:95], a[72:75], a[168:171], v[92:95]
  v_mfma_f32_16x16x32_bf16 v[96:99], a[76:79], a[168:171], v[96:99]
  buffer_load_dwordx4 a[244:247], v1, s[8:11], s45 offen offset:1024 sc1
  s_waitcnt vmcnt(14)
  v_mfma_f32_16x16x32_bf16 v[100:103], a[60:63], a[172:175], v[100:103]
  v_mfma_f32_16x16x32_bf16 v[104:107], a[64:67], a[172:175], v[104:107]
  v_mfma_f32_16x16x32_bf16 v[108:111], a[68:71], a[172:175], v[108:111]
  v_mfma_f32_16x16x32_bf16 v[112:115], a[72:75], a[172:175], v[112:115]
  buffer_load_dwordx4 a[200:203], v1, s[8:11], s46 offen offset:2048 sc1
  v_mfma_f32_16x16x32_bf16 v[116:119], a[76:79], a[172:175], v[116:119]
  s_waitcnt vmcnt(14)
  v_mfma_f32_16x16x32_bf16 v[120:123], a[60:63], a[176:179], v[120:123]
  v_mfma_f32_16x16x32_bf16 v[124:127], a[64:67], a[176:179], v[124:127]
  v_mfma_f32_16x16x32_bf16 v[128:131], a[68:71], a[176:179], v[128:131]
  buffer_load_dwordx4 a[204:207], v1, s[8:11], s46 offen offset:3072 sc1
  v_mfma_f32_16x16x32_bf16 v[132:135], a[72:75], a[176:179], v[132:135]
  v_mfma_f32_16x16x32_bf16 v[136:139], a[76:79], a[176:179], v[136:139]
  s_waitcnt vmcnt(14)
  v_mfma_f32_16x16x32_bf16 v[140:143], a[60:63], a[136:139], v[140:143]
  v_mfma_f32_16x16x32_bf16 v[144:147], a[64:67], a[136:139], v[144:147]
  s_add_u32 s46, s46, 4096
  s_add_u32 s46, s46, s53
  buffer_load_dwordx4 a[208:211], v1, s[8:11], s46 offen offset:0 sc1
  v_mfma_f32_16x16x32_bf16 v[148:151], a[68:71], a[136:139], v[148:151]
  v_mfma_f32_16x16x32_bf16 v[152:155], a[72:75], a[136:139], v[152:155]
  v_mfma_f32_16x16x32_bf16 v[156:159], a[76:79], a[136:139], v[156:159]
  s_waitcnt vmcnt(14)
  v_mfma_f32_16x16x32_bf16 v[80:83], a[80:83], a[140:143], v[80:83]
  buffer_load_dwordx4 a[212:215], v1, s[8:11], s46 offen offset:1024 sc1
  v_mfma_f32_16x16x32_bf16 v[84:87], a[84:87], a[140:143], v[84:87]
  v_mfma_f32_16x16x32_bf16 v[88:91], a[88:91], a[140:143], v[88:91]
  v_mfma_f32_16x16x32_bf16 v[92:95], a[92:95], a[140:143], v[92:95]
  v_mfma_f32_16x16x32_bf16 v[96:99], a[96:99], a[140:143], v[96:99]
  buffer_load_dwordx4 a[216:219], v1, s[8:11], s47 offen offset:2048 sc1
  s_waitcnt vmcnt(15)
  v_mfma_f32_16x16x32_bf16 v[100:103], a[80:83], a[144:147], v[100:103]
  v_mfma_f32_16x16x32_bf16 v[104:107], a[84:87], a[144:147], v[104:107]
  v_mfma_f32_16x16x32_bf16 v[108:111], a[88:91], a[144:147], v[108:111]
  v_mfma_f32_16x16x32_bf16 v[112:115], a[92:95], a[144:147], v[112:115]
  buffer_load_dwordx4 a[248:251], v1, s[8:11], s47 offen offset:3072 sc1
  v_mfma_f32_16x16x32_bf16 v[116:119], a[96:99], a[144:147], v[116:119]
  s_waitcnt vmcnt(15)
  v_mfma_f32_16x16x32_bf16 v[120:123], a[80:83], a[148:151], v[120:123]
  v_mfma_f32_16x16x32_bf16 v[124:127], a[84:87], a[148:151], v[124:127]
  v_mfma_f32_16x16x32_bf16 v[128:131], a[88:91], a[148:151], v[128:131]
  s_add_u32 s47, s47, 4096
  s_add_u32 s47, s47, s53
  buffer_load_dwordx4 a[252:255], v1, s[8:11], s47 offen offset:0 sc1
  v_mfma_f32_16x16x32_bf16 v[132:135], a[92:95], a[148:151], v[132:135]
  v_mfma_f32_16x16x32_bf16 v[136:139], a[96:99], a[148:151], v[136:139]
  s_waitcnt vmcnt(15)
  v_mfma_f32_16x16x32_bf16 v[140:143], a[80:83], a[180:183], v[140:143]
  v_mfma_f32_16x16x32_bf16 v[144:147], a[84:87], a[180:183], v[144:147]
  buffer_load_dwordx4 v[212:215], v1, s[8:11], s47 offen offset:1024 sc1
  v_mfma_f32_16x16x32_bf16 v[148:151], a[88:91], a[180:183], v[148:151]
  v_mfma_f32_16x16x32_bf16 v[152:155], a[92:95], a[180:183], v[152:155]
  v_mfma_f32_16x16x32_bf16 v[156:159], a[96:99], a[180:183], v[156:159]
  s_waitcnt vmcnt(15)
  v_mfma_f32_16x16x32_bf16 v[80:83], a[100:103], a[184:187], v[80:83]
  buffer_load_dwordx4 v1, s[8:11], s28 offen offset:2048 sc1 lds
  v_mfma_f32_16x16x32_bf16 v[84:87], a[104:107], a[184:187], v[84:87]
  v_mfma_f32_16x16x32_bf16 v[88:91], a[108:111], a[184:187], v[88:91]
  v_mfma_f32_16x16x32_bf16 v[92:95], a[112:115], a[184:187], v[92:95]
  v_mfma_f32_16x16x32_bf16 v[96:99], a[116:119], a[184:187], v[96:99]
  buffer_load_dwordx4 v1, s[8:11], s28 offen offset:3072 sc1 lds
  s_waitcnt vmcnt(16)
  v_mfma_f32_16x16x32_bf16 v[80:83], v[16:19], a[188:191], v[80:83]
  v_mfma_f32_16x16x32_bf16 v[84:87], v[20:23], a[188:191], v[84:87]
  v_mfma_f32_16x16x32_bf16 v[88:91], v[24:27], a[188:191], v[88:91]
  v_mfma_f32_16x16x32_bf16 v[92:95], v[28:31], a[188:191], v[92:95]
  s_add_u32 s28, s54, 1839104
  s_add_u32 m0, s55, 4096
  s_nop 0
  buffer_load_dwordx4 v1, s[8:11], s28 offen offset:0 sc1 lds
  v_mfma_f32_16x16x32_bf16 v[96:99], v[32:35], a[188:191], v[96:99]
  s_waitcnt vmcnt(16)
  v_mfma_f32_16x16x32_bf16 v[80:83], v[36:39], a[192:195], v[80:83]
  v_mfma_f32_16x16x32_bf16 v[84:87], v[40:43], a[192:195], v[84:87]
  v_mfma_f32_16x16x32_bf16 v[88:91], v[44:47], a[192:195], v[88:91]
  buffer_load_dwordx4 v1, s[8:11], s28 offen offset:1024 sc1 lds
  v_mfma_f32_16x16x32_bf16 v[92:95], v[48:51], a[192:195], v[92:95]
  v_mfma_f32_16x16x32_bf16 v[96:99], v[52:55], a[192:195], v[96:99]
  s_waitcnt vmcnt(16)
  v_mfma_f32_16x16x32_bf16 v[80:83], v[56:59], a[196:199], v[80:83]
  v_mfma_f32_16x16x32_bf16 v[84:87], v[60:63], a[196:199], v[84:87]
  buffer_load_dwordx4 v1, s[8:11], s28 offen offset:2048 sc1 lds
  v_mfma_f32_16x16x32_bf16 v[88:91], v[64:67], a[196:199], v[88:91]
  v_mfma_f32_16x16x32_bf16 v[92:95], v[68:71], a[196:199], v[92:95]
  v_mfma_f32_16x16x32_bf16 v[96:99], v[72:75], a[196:199], v[96:99]
  s_waitcnt vmcnt(16)
  v_mfma_f32_16x16x32_bf16 v[100:103], a[100:103], a[152:155], v[100:103]
  buffer_load_dwordx4 v1, s[8:11], s28 offen offset:3072 sc1 lds
  v_mfma_f32_16x16x32_bf16 v[104:107], a[104:107], a[152:155], v[104:107]
  v_mfma_f32_16x16x32_bf16 v[108:111], a[108:111], a[152:155], v[108:111]
  v_mfma_f32_16x16x32_bf16 v[112:115], a[112:115], a[152:155], v[112:115]
  s_add_u32 s31, s18, 1
  s_and_b32 s31, s31, 3
  v_mfma_f32_16x16x32_bf16 v[116:119], a[116:119], a[152:155], v[116:119]
  s_mul_i32 s31, s31, 15360
  s_add_u32 s31, s31, 102400
  s_waitcnt vmcnt(16)
  v_mfma_f32_16x16x32_bf16 v[100:103], v[16:19], a[156:159], v[100:103]
  v_add_u32 v226, s31, v1
  ds_write_b128 v226, v[80:83] offset:0
  v_mfma_f32_16x16x32_bf16 v[104:107], v[20:23], a[156:159], v[104:107]
  v_mfma_f32_16x16x32_bf16 v[108:111], v[24:27], a[156:159], v[108:111]
  ds_write_b128 v226, v[84:87] offset:1024
  v_mfma_f32_16x16x32_bf16 v[112:115], v[28:31], a[156:159], v[112:115]
  v_mfma_f32_16x16x32_bf16 v[116:119], v[32:35], a[156:159], v[116:119]
  ds_write_b128 v226, v[88:91] offset:2048
  s_waitcnt vmcnt(15)
  v_mfma_f32_16x16x32_bf16 v[100:103], v[36:39], a[240:243], v[100:103]
  v_mfma_f32_16x16x32_bf16 v[104:107], v[40:43], a[240:243], v[104:107]
  ds_write_b128 v226, v[92:95] offset:3072
  v_mfma_f32_16x16x32_bf16 v[108:111], v[44:47], a[240:243], v[108:111]
  v_mfma_f32_16x16x32_bf16 v[112:115], v[48:51], a[240:243], v[112:115]
  ds_write_b128 v226, v[96:99] offset:4096
  v_mfma_f32_16x16x32_bf16 v[116:119], v[52:55], a[240:243], v[116:119]
  s_waitcnt vmcnt(14)
  v_mfma_f32_16x16x32_bf16 v[100:103], v[56:59], a[244:247], v[100:103]
  v_mfma_f32_16x16x32_bf16 v[104:107], v[60:63], a[244:247], v[104:107]
  v_mfma_f32_16x16x32_bf16 v[108:111], v[64:67], a[244:247], v[108:111]
  v_mfma_f32_16x16x32_bf16 v[112:115], v[68:71], a[244:247], v[112:115]
  v_mfma_f32_16x16x32_bf16 v[116:119], v[72:75], a[244:247], v[116:119]
  s_waitcnt vmcnt(13)
  v_mfma_f32_16x16x32_bf16 v[120:123], a[100:103], a[200:203], v[120:123]
  v_mfma_f32_16x16x32_bf16 v[124:127], a[104:107], a[200:203], v[124:127]
  v_mfma_f32_16x16x32_bf16 v[128:131], a[108:111], a[200:203], v[128:131]
  v_mfma_f32_16x16x32_bf16 v[132:135], a[112:115], a[200:203], v[132:135]
  s_add_u32 s31, s18, 2
  s_and_b32 s31, s31, 3
  v_mfma_f32_16x16x32_bf16 v[136:139], a[116:119], a[200:203], v[136:139]
  s_mul_i32 s31, s31, 15360
  s_add_u32 s31, s31, 107520
  s_waitcnt vmcnt(12)
  v_mfma_f32_16x16x32_bf16 v[120:123], v[16:19], a[204:207], v[120:123]
  v_add_u32 v226, s31, v1
  ds_write_b128 v226, v[100:103] offset:0
  v_mfma_f32_16x16x32_bf16 v[124:127], v[20:23], a[204:207], v[124:127]
  v_mfma_f32_16x16x32_bf16 v[128:131], v[24:27], a[204:207], v[128:131]
  ds_write_b128 v226, v[104:107] offset:1024
  v_mfma_f32_16x16x32_bf16 v[132:135], v[28:31], a[204:207], v[132:135]
  v_mfma_f32_16x16x32_bf16 v[136:139], v[32:35], a[204:207], v[136:139]
  ds_write_b128 v226, v[108:111] offset:2048
  s_waitcnt vmcnt(11)
  v_mfma_f32_16x16x32_bf16 v[120:123], v[36:39], a[208:211], v[120:123]
  v_mfma_f32_16x16x32_bf16 v[124:127], v[40:43], a[208:211], v[124:127]
  ds_write_b128 v226, v[112:115] offset:3072
  v_mfma_f32_16x16x32_bf16 v[128:131], v[44:47], a[208:211], v[128:131]
  v_mfma_f32_16x16x32_bf16 v[132:135], v[48:51], a[208:211], v[132:135]
  ds_write_b128 v226, v[116:119] offset:4096
  v_mfma_f32_16x16x32_bf16 v[136:139], v[52:55], a[208:211], v[136:139]
  s_waitcnt vmcnt(10)
  v_mfma_f32_16x16x32_bf16 v[120:123], v[56:59], a[212:215], v[120:123]
  v_mfma_f32_16x16x32_bf16 v[124:127], v[60:63], a[212:215], v[124:127]
  v_mfma_f32_16x16x32_bf16 v[128:131], v[64:67], a[212:215], v[128:131]
  v_mfma_f32_16x16x32_bf16 v[132:135], v[68:71], a[212:215], v[132:135]
  v_mfma_f32_16x16x32_bf16 v[136:139], v[72:75], a[212:215], v[136:139]
  s_waitcnt vmcnt(9)
  v_mfma_f32_16x16x32_bf16 v[140:143], a[100:103], a[216:219], v[140:143]
  v_mfma_f32_16x16x32_bf16 v[144:147], a[104:107], a[216:219], v[144:147]
  v_mfma_f32_16x16x32_bf16 v[148:151], a[108:111], a[216:219], v[148:151]
  v_mfma_f32_16x16x32_bf16 v[152:155], a[112:115], a[216:219], v[152:155]
  s_add_u32 s31, s18, 3
  s_and_b32 s31, s31, 3
  v_mfma_f32_16x16x32_bf16 v[156:159], a[116:119], a[216:219], v[156:159]
  s_mul_i32 s31, s31, 15360
  s_add_u32 s31, s31, 112640
  s_waitcnt vmcnt(8)
  v_mfma_f32_16x16x32_bf16 v[140:143], v[16:19], a[248:251], v[140:143]
  v_add_u32 v226, s31, v1
  ds_write_b128 v226, v[120:123] offset:0
  v_mfma_f32_16x16x32_bf16 v[144:147], v[20:23], a[248:251], v[144:147]
  v_mfma_f32_16x16x32_bf16 v[148:151], v[24:27], a[248:251], v[148:151]
  ds_write_b128 v226, v[124:127] offset:1024
  v_mfma_f32_16x16x32_bf16 v[152:155], v[28:31], a[248:251], v[152:155]
  v_mfma_f32_16x16x32_bf16 v[156:159], v[32:35], a[248:251], v[156:159]
  ds_write_b128 v226, v[128:131] offset:2048
  s_waitcnt vmcnt(7)
  v_mfma_f32_16x16x32_bf16 v[140:143], v[36:39], a[252:255], v[140:143]
  v_mfma_f32_16x16x32_bf16 v[144:147], v[40:43], a[252:255], v[144:147]
  ds_write_b128 v226, v[132:135] offset:3072
  v_mfma_f32_16x16x32_bf16 v[148:151], v[44:47], a[252:255], v[148:151]
  v_mfma_f32_16x16x32_bf16 v[152:155], v[48:51], a[252:255], v[152:155]
  ds_write_b128 v226, v[136:139] offset:4096
  v_mfma_f32_16x16x32_bf16 v[156:159], v[52:55], a[252:255], v[156:159]
  s_waitcnt vmcnt(6)
  v_mfma_f32_16x16x32_bf16 v[140:143], v[56:59], v[212:215], v[140:143]
  v_mfma_f32_16x16x32_bf16 v[144:147], v[60:63], v[212:215], v[144:147]
  v_mfma_f32_16x16x32_bf16 v[148:151], v[64:67], v[212:215], v[148:151]
  v_mfma_f32_16x16x32_bf16 v[152:155], v[68:71], v[212:215], v[152:155]
  v_mfma_f32_16x16x32_bf16 v[156:159], v[72:75], v[212:215], v[156:159]
  s_nop 3
  v_pk_add_f32 v[236:237], v[236:237], v[140:141]
  v_pk_add_f32 v[238:239], v[238:239], v[142:143]
  v_pk_add_f32 v[240:241], v[240:241], v[144:145]
  v_pk_add_f32 v[242:243], v[242:243], v[146:147]
  v_pk_add_f32 v[244:245], v[244:245], v[148:149]
  v_pk_add_f32 v[246:247], v[246:247], v[150:151]
  v_pk_add_f32 v[248:249], v[248:249], v[152:153]
  v_pk_add_f32 v[250:251], v[250:251], v[154:155]
  v_pk_add_f32 v[252:253], v[252:253], v[156:157]
  v_pk_add_f32 v[254:255], v[254:255], v[158:159]
  s_mul_i32 s33, s18, 15360
  s_add_u32 s33, s33, 102400
  v_add_u32 v176, s33, v1
  s_add_u32 s28, s54, 1843200
  s_add_u32 m0, s55, 8192
  s_nop 0
  buffer_load_dwordx4 v1, s[8:11], s28 offen offset:0 sc1 lds
  buffer_load_dwordx4 v1, s[8:11], s28 offen offset:1024 sc1 lds
  s_waitcnt lgkmcnt(0)
  s_barrier
  ds_read_b128 v[16:19], v176 offset:0
  ds_read_b128 v[20:23], v176 offset:1024
  ds_read_b128 v[24:27], v176 offset:2048
  ds_read_b128 v[28:31], v176 offset:3072
  ds_read_b128 v[32:35], v176 offset:4096
  ds_read_b128 v[36:39], v176 offset:5120
  ds_read_b128 v[40:43], v176 offset:6144
  ds_read_b128 v[44:47], v176 offset:7168
  ds_read_b128 v[48:51], v176 offset:8192
  ds_read_b128 v[52:55], v176 offset:9216
  ds_read_b128 v[56:59], v176 offset:10240
  ds_read_b128 v[60:63], v176 offset:11264
  ds_read_b128 v[64:67], v176 offset:12288
  ds_read_b128 v[68:71], v176 offset:13312
  ds_read_b128 v[72:75], v176 offset:14336
  buffer_load_dwordx4 v1, s[8:11], s28 offen offset:2048 sc1 lds
  buffer_load_dwordx4 v1, s[8:11], s28 offen offset:3072 sc1 lds
  s_lshl_b32 s35, s19, 1
  s_add_u32 s35, s35, 2
  s_lshl_b32 s36, s16, 3
  s_lshl_b32 s37, s21, 2
  s_add_u32 s36, s36, s37
  s_add_u32 s36, s36, s18
  s_mul_i32 s33, s35, 2621440
  s_lshr_b32 s37, s36, 1
  s_mul_i32 s37, s37, 40960
  s_add_u32 s33, s33, s37
  s_and_b32 s37, s36, 1
  s_lshl_b32 s37, s37, 8
  s_add_u32 s33, s33, s37
  s_mul_i32 s37, s20, 5120
  s_add_u32 s33, s33, s37
  s_add_u32 s33, s33, 13357056
  s_add_u32 s34, s33, 4096
  s_mul_i32 s35, s35, 131072
  s_lshl_b32 s37, s20, 14
  s_add_u32 s35, s35, s37
  s_lshl_b32 s37, s36, 7
  s_add_u32 s35, s35, s37
  s_add_u32 s35, s35, 23842816
  s_add_u32 s28, s54, 1847296
  s_add_u32 m0, s55, 12288
  s_nop 0
  buffer_load_dwordx4 v1, s[8:11], s28 offen offset:0 sc1 lds
  s_waitcnt lgkmcnt(10)
  v_pk_add_f32 v[236:237], v[236:237], v[16:17]
  v_pk_add_f32 v[238:239], v[238:239], v[18:19]
  v_pk_add_f32 v[240:241], v[240:241], v[20:21]
  v_pk_add_f32 v[242:243], v[242:243], v[22:23]
  v_pk_add_f32 v[244:245], v[244:245], v[24:25]
  v_pk_add_f32 v[246:247], v[246:247], v[26:27]
  v_pk_add_f32 v[248:249], v[248:249], v[28:29]
  v_pk_add_f32 v[250:251], v[250:251], v[30:31]
  v_pk_add_f32 v[252:253], v[252:253], v[32:33]
  v_pk_add_f32 v[254:255], v[254:255], v[34:35]
  buffer_load_dwordx4 v1, s[8:11], s28 offen offset:1024 sc1 lds
  s_waitcnt lgkmcnt(5)
  v_pk_add_f32 v[236:237], v[236:237], v[36:37]
  v_pk_add_f32 v[238:239], v[238:239], v[38:39]
  v_pk_add_f32 v[240:241], v[240:241], v[40:41]
  v_pk_add_f32 v[242:243], v[242:243], v[42:43]
  v_pk_add_f32 v[244:245], v[244:245], v[44:45]
  v_pk_add_f32 v[246:247], v[246:247], v[46:47]
  v_pk_add_f32 v[248:249], v[248:249], v[48:49]
  v_pk_add_f32 v[250:251], v[250:251], v[50:51]
  v_pk_add_f32 v[252:253], v[252:253], v[52:53]
  v_pk_add_f32 v[254:255], v[254:255], v[54:55]
  buffer_load_dwordx4 v1, s[8:11], s28 offen offset:2048 sc1 lds
  s_waitcnt lgkmcnt(0)
  v_pk_add_f32 v[236:237], v[236:237], v[56:57]
  v_pk_add_f32 v[238:239], v[238:239], v[58:59]
  v_pk_add_f32 v[240:241], v[240:241], v[60:61]
  v_pk_add_f32 v[242:243], v[242:243], v[62:63]
  v_pk_add_f32 v[244:245], v[244:245], v[64:65]
  v_pk_add_f32 v[246:247], v[246:247], v[66:67]
  v_pk_add_f32 v[248:249], v[248:249], v[68:69]
  v_pk_add_f32 v[250:251], v[250:251], v[70:71]
  v_pk_add_f32 v[252:253], v[252:253], v[72:73]
  v_pk_add_f32 v[254:255], v[254:255], v[74:75]
  v_cvt_pk_bf16_f32 v160, v236, v237
  v_cvt_pk_bf16_f32 v161, v238, v239
  v_cvt_pk_bf16_f32 v162, v240, v241
  v_cvt_pk_bf16_f32 v163, v242, v243
  v_cvt_pk_bf16_f32 v164, v244, v245
  v_cvt_pk_bf16_f32 v165, v246, v247
  v_cvt_pk_bf16_f32 v166, v248, v249
  v_cvt_pk_bf16_f32 v167, v250, v251
  v_cvt_pk_bf16_f32 v168, v252, v253
  v_cvt_pk_bf16_f32 v169, v254, v255
  s_cmp_eq_u32 s19, 1
  s_cbranch_scc1 L_final
  buffer_store_dwordx4 v[160:163], v10, s[8:11], s33 offen sc1
  buffer_store_dwordx4 v[164:167], v10, s[8:11], s33 offen offset:2048 sc1
  buffer_store_dwordx2 v[168:169], v11, s[8:11], s34 offen sc1
  v_pk_mul_f32 v[174:175], v[236:237], v[236:237]
  v_pk_add_f32 v[172:173], v[236:237], v[238:239]
  v_pk_fma_f32 v[174:175], v[238:239], v[238:239], v[174:175]
  v_pk_fma_f32 v[174:175], v[240:241], v[240:241], v[174:175]
  v_pk_add_f32 v[172:173], v[172:173], v[240:241]
  v_pk_fma_f32 v[174:175], v[242:243], v[242:243], v[174:175]
  v_pk_add_f32 v[172:173], v[172:173], v[242:243]
  v_pk_fma_f32 v[174:175], v[244:245], v[244:245], v[174:175]
  v_pk_add_f32 v[172:173], v[172:173], v[244:245]
  v_pk_fma_f32 v[174:175], v[246:247], v[246:247], v[174:175]
  v_pk_add_f32 v[172:173], v[172:173], v[246:247]
  v_pk_fma_f32 v[174:175], v[248:249], v[248:249], v[174:175]
  v_pk_add_f32 v[172:173], v[172:173], v[248:249]
  v_pk_fma_f32 v[174:175], v[250:251], v[250:251], v[174:175]
  v_pk_add_f32 v[172:173], v[172:173], v[250:251]
  v_pk_fma_f32 v[174:175], v[252:253], v[252:253], v[174:175]
  v_pk_add_f32 v[172:173], v[172:173], v[252:253]
  v_pk_fma_f32 v[174:175], v[254:255], v[254:255], v[174:175]
  v_pk_add_f32 v[172:173], v[172:173], v[254:255]
  v_add_f32 v172, v172, v173
  v_add_f32 v173, v174, v175
  v_mov_b32 v174, v172
  v_mov_b32 v175, v173
  s_nop 0
  v_permlane32_swap_b32 v172, v174
  v_permlane32_swap_b32 v173, v175
  v_pk_add_f32 v[172:173], v[172:173], v[174:175]
  v_mov_b32 v174, v172
  v_mov_b32 v175, v173
  s_nop 0
  v_permlane16_swap_b32 v172, v174
  v_permlane16_swap_b32 v173, v175
  v_pk_add_f32 v[172:173], v[172:173], v[174:175]
  v_lshrrev_b32 v174, 1, v1
  s_mov_b64 exec, 0xffff
  buffer_store_dwordx2 v[172:173], v174, s[8:11], s35 offen sc1
  s_mov_b64 exec, -1
  s_mul_i32 s30, s19, 917504
  s_lshl_b32 s31, s16, 13
  s_add_u32 s30, s30, s31
  s_add_u32 s30, s30, 393216
  s_add_u32 s30, s30, s22
  v_mov_b32 v14, s25
  s_waitcnt vmcnt(0)
  s_mov_b64 exec, 1
  buffer_store_dword v14, v4, s[8:11], s30 offen sc1
  s_mov_b64 exec, -1
  buffer_load_dwordx4 v1, s[8:11], s28 offen offset:3072 sc1 lds
  s_add_u32 s28, s54, 1851392
  s_add_u32 m0, s55, 16384
  s_nop 0
  buffer_load_dwordx4 v1, s[8:11], s28 offen offset:0 sc1 lds
  buffer_load_dwordx4 v1, s[8:11], s28 offen offset:1024 sc1 lds
  buffer_load_dwordx4 v1, s[8:11], s28 offen offset:2048 sc1 lds
  buffer_load_dwordx4 v1, s[8:11], s28 offen offset:3072 sc1 lds
  s_add_u32 s28, s54, 1855488
  s_add_u32 m0, s55, 20480
  s_nop 0
  buffer_load_dwordx4 v1, s[8:11], s28 offen offset:0 sc1 lds
  buffer_load_dwordx4 v1, s[8:11], s28 offen offset:1024 sc1 lds
  buffer_load_dwordx4 v1, s[8:11], s28 offen offset:2048 sc1 lds
  buffer_load_dwordx4 v1, s[8:11], s28 offen offset:3072 sc1 lds
  s_add_u32 s28, s54, 1859584
  s_add_u32 m0, s55, 24576
  s_nop 0
  buffer_load_dwordx4 v1, s[8:11], s28 offen offset:0 sc1 lds
  s_barrier
  s_mul_i32 s54, s17, 163840
  s_mul_i32 s55, s18, 5120
  s_add_u32 s54, s54, s55
  s_add_u32 s28, s54, 1937408
  s_add_u32 m0, s55, 102400
  s_nop 0
  buffer_load_dwordx4 v1, s[8:11], s28 offen offset:0 sc1 lds
  buffer_load_dwordx4 v1, s[8:11], s28 offen offset:1024 sc1 lds
  buffer_load_dwordx4 v1, s[8:11], s28 offen offset:2048 sc1 lds
  buffer_load_dwordx4 v1, s[8:11], s28 offen offset:3072 sc1 lds
  s_add_u32 s28, s54, 1941504
  s_add_u32 m0, s55, 106496
  s_nop 0
  buffer_load_dwordx4 v1, s[8:11], s28 offen offset:0 sc1 lds
  s_mov_b32 s19, 1
  v_mov_b32 v200, 0x70000000
  v_mov_b32 v201, 0x70000000
  v_mov_b32 v202, 0x70000000
  v_mov_b32 v203, 0x70000000
  v_mov_b32 v204, 0x70000000
  v_mov_b32 v205, 0x70000000
  v_mov_b32 v206, 0x70000000
  v_mov_b32 v207, 0x70000000
  v_mov_b32 v208, 0x70000000
  s_mul_i32 s24, s19, 917504
  s_lshl_b32 s31, s16, 13
  s_add_u32 s24, s24, s31
  s_add_u32 s24, s24, -524288
  s_lshr_b32 s31, s18, 1
  s_lshl_b32 s31, s31, 11
  s_add_u32 s24, s24, s31
  s_and_b32 s31, s18, 1
  s_lshl_b32 s31, s31, 8
  s_add_u32 s24, s24, s31
  v_and_b32 v225, 4, v5
  v_lshlrev_b32 v225, 10, v225
  v_and_b32 v224, 3, v5
  v_lshl_add_u32 v225, v224, 9, v225
  v_bfe_u32 v224, v5, 3, 1
  v_lshl_add_u32 v225, v224, 7, v225
  v_mov_b32 v224, s25
  s_mov_b64 exec, 0xffff
  buffer_load_dword v224, v225, s[8:11], s24 offen sc1
  s_mov_b64 exec, -1
  s_waitcnt vmcnt(0)
  v_cmp_ne_u32 vcc, s25, v224
  s_cbranch_vccz PL_10_k
  s_mov_b32 s32, 0x40000
  s_mov_b64 exec, 0xffff
PL_10_p:
  buffer_load_dword v224, v225, s[8:11], s24 offen sc1
  s_sub_u32 s32, s32, 1
  s_cbranch_scc1 PL_10_d
  s_waitcnt vmcnt(0)
  v_cmp_ne_u32 vcc, s25, v224
  s_cbranch_vccnz PL_10_p
PL_10_d:
  s_mov_b64 exec, -1
PL_10_k:
  s_branch L_layer
L_final:
  buffer_store_dwordx4 v[160:163], v12, s[12:15], s89 offen
  buffer_store_dwordx4 v[164:167], v12, s[12:15], s89 offen offset:64
  buffer_store_dwordx2 v[168:169], v13, s[12:15], s89 offen offset:128
L_end:
  s_endpgm
L_slow:
  s_cmp_lg_u32 s26, 0
  s_cbranch_scc1 L_attdone
  s_mov_b32 s26, 1
  v_cndmask_b32 v16, v4, v135, s[56:57]
  v_cndmask_b32 v17, v4, v135, s[58:59]
  v_cndmask_b32 v18, v4, v135, s[60:61]
  v_cndmask_b32 v19, v4, v135, s[62:63]
  v_cndmask_b32 v20, v4, v135, s[64:65]
  v_cndmask_b32 v21, v4, v135, s[66:67]
  v_cndmask_b32 v22, v4, v135, s[68:69]
  v_cndmask_b32 v23, v4, v135, s[70:71]
  v_cndmask_b32 v24, v4, v135, s[72:73]
  v_cndmask_b32 v25, v4, v135, s[74:75]
  v_cndmask_b32 v26, v4, v135, s[76:77]
  v_cndmask_b32 v27, v4, v135, s[78:79]
  v_cndmask_b32 v28, v4, v135, s[80:81]
  v_cndmask_b32 v29, v4, v135, s[82:83]
  v_cndmask_b32 v30, v4, v135, s[84:85]
  v_cndmask_b32 v31, v4, v135, s[86:87]
  s_nop 1
  v_mfma_f32_32x32x16_bf16 v[16:31], a[0:3], v[216:219], v[16:31]
  v_mfma_f32_32x32x8_bf16 v[16:31], a[72:73], v[228:229], v[16:31]
  s_nop 11
  v_max3_f32 v133, v16, v17, v133
  v_max3_f32 v133, v18, v19, v133
  v_max3_f32 v133, v20, v21, v133
  v_max3_f32 v133, v22, v23, v133
  v_max3_f32 v133, v24, v25, v133
  v_max3_f32 v133, v26, v27, v133
  v_max3_f32 v133, v28, v29, v133
  v_max3_f32 v133, v30, v31, v133
  v_mfma_f32_32x32x16_bf16 v[16:31], a[4:7], v[216:219], 0
  v_mfma_f32_32x32x8_bf16 v[16:31], a[74:75], v[228:229], v[16:31]
  s_nop 11
  v_max3_f32 v133, v16, v17, v133
  v_max3_f32 v133, v18, v19, v133
  v_max3_f32 v133, v20, v21, v133
  v_max3_f32 v133, v22, v23, v133
  v_max3_f32 v133, v24, v25, v133
  v_max3_f32 v133, v26, v27, v133
  v_max3_f32 v133, v28, v29, v133
  v_max3_f32 v133, v30, v31, v133
  v_mfma_f32_32x32x16_bf16 v[16:31], a[8:11], v[216:219], 0
  v_mfma_f32_32x32x8_bf16 v[16:31], a[76:77], v[228:229], v[16:31]
  s_nop 11
  v_max3_f32 v133, v16, v17, v133
  v_max3_f32 v133, v18, v19, v133
  v_max3_f32 v133, v20, v21, v133
  v_max3_f32 v133, v22, v23, v133
  v_max3_f32 v133, v24, v25, v133
  v_max3_f32 v133, v26, v27, v133
  v_max3_f32 v133, v28, v29, v133
  v_max3_f32 v133, v30, v31, v133
  v_mfma_f32_32x32x16_bf16 v[16:31], a[12:15], v[216:219], 0
  v_mfma_f32_32x32x8_bf16 v[16:31], a[78:79], v[228:229], v[16:31]
  s_nop 11
  v_max3_f32 v133, v16, v17, v133
  v_max3_f32 v133, v18, v19, v133
  v_max3_f32 v133, v20, v21, v133
  v_max3_f32 v133, v22, v23, v133
  v_max3_f32 v133, v24, v25, v133
  v_max3_f32 v133, v26, v27, v133
  v_max3_f32 v133, v28, v29, v133
  v_max3_f32 v133, v30, v31, v133
  v_mfma_f32_32x32x16_bf16 v[16:31], a[16:19], v[216:219], 0
  v_mfma_f32_32x32x8_bf16 v[16:31], a[80:81], v[228:229], v[16:31]
  s_nop 11
  v_max3_f32 v133, v16, v17, v133
  v_max3_f32 v133, v18, v19, v133
  v_max3_f32 v133, v20, v21, v133
  v_max3_f32 v133, v22, v23, v133
  v_max3_f32 v133, v24, v25, v133
  v_max3_f32 v133, v26, v27, v133
  v_max3_f32 v133, v28, v29, v133
  v_max3_f32 v133, v30, v31, v133
  v_mfma_f32_32x32x16_bf16 v[16:31], a[20:23], v[216:219], 0
  v_mfma_f32_32x32x8_bf16 v[16:31], a[82:83], v[228:229], v[16:31]
  s_nop 11
  v_max3_f32 v133, v16, v17, v133
  v_max3_f32 v133, v18, v19, v133
  v_max3_f32 v133, v20, v21, v133
  v_max3_f32 v133, v22, v23, v133
  v_max3_f32 v133, v24, v25, v133
  v_max3_f32 v133, v26, v27, v133
  v_max3_f32 v133, v28, v29, v133
  v_max3_f32 v133, v30, v31, v133
  v_mfma_f32_32x32x16_bf16 v[16:31], a[24:27], v[216:219], 0
  v_mfma_f32_32x32x8_bf16 v[16:31], a[84:85], v[228:229], v[16:31]
  s_nop 11
  v_max3_f32 v133, v16, v17, v133
  v_max3_f32 v133, v18, v19, v133
  v_max3_f32 v133, v20, v21, v133
  v_max3_f32 v133, v22, v23, v133
  v_max3_f32 v133, v24, v25, v133
  v_max3_f32 v133, v26, v27, v133
  v_max3_f32 v133, v28, v29, v133
  v_max3_f32 v133, v30, v31, v133
  v_mfma_f32_32x32x16_bf16 v[16:31], a[28:31], v[216:219], 0
  v_mfma_f32_32x32x8_bf16 v[16:31], a[86:87], v[228:229], v[16:31]
  s_nop 11
  v_max3_f32 v133, v16, v17, v133
  v_max3_f32 v133, v18, v19, v133
  v_max3_f32 v133, v20, v21, v133
  v_max3_f32 v133, v22, v23, v133
  v_max3_f32 v133, v24, v25, v133
  v_max3_f32 v133, v26, v27, v133
  v_max3_f32 v133, v28, v29, v133
  v_max3_f32 v133, v30, v31, v133
  v_cndmask_b32 v16, v4, v135, s[56:57]
  v_cndmask_b32 v17, v4, v135, s[58:59]
  v_cndmask_b32 v18, v4, v135, s[60:61]
  v_cndmask_b32 v19, v4, v135, s[62:63]
  v_cndmask_b32 v20, v4, v135, s[64:65]
  v_cndmask_b32 v21, v4, v135, s[66:67]
  v_cndmask_b32 v22, v4, v135, s[68:69]
  v_cndmask_b32 v23, v4, v135, s[70:71]
  v_cndmask_b32 v24, v4, v135, s[72:73]
  v_cndmask_b32 v25, v4, v135, s[74:75]
  v_cndmask_b32 v26, v4, v135, s[76:77]
  v_cndmask_b32 v27, v4, v135, s[78:79]
  v_cndmask_b32 v28, v4, v135, s[80:81]
  v_cndmask_b32 v29, v4, v135, s[82:83]
  v_cndmask_b32 v30, v4, v135, s[84:85]
  v_cndmask_b32 v31, v4, v135, s[86:87]
  s_nop 1
  v_mfma_f32_32x32x16_bf16 v[16:31], a[36:39], v[220:223], v[16:31]
  v_mfma_f32_32x32x8_bf16 v[16:31], a[72:73], v[230:231], v[16:31]
  s_nop 11
  v_max3_f32 v134, v16, v17, v134
  v_max3_f32 v134, v18, v19, v134
  v_max3_f32 v134, v20, v21, v134
  v_max3_f32 v134, v22, v23, v134
  v_max3_f32 v134, v24, v25, v134
  v_max3_f32 v134, v26, v27, v134
  v_max3_f32 v134, v28, v29, v134
  v_max3_f32 v134, v30, v31, v134
  v_mfma_f32_32x32x16_bf16 v[16:31], a[40:43], v[220:223], 0
  v_mfma_f32_32x32x8_bf16 v[16:31], a[74:75], v[230:231], v[16:31]
  s_nop 11
  v_max3_f32 v134, v16, v17, v134
  v_max3_f32 v134, v18, v19, v134
  v_max3_f32 v134, v20, v21, v134
  v_max3_f32 v134, v22, v23, v134
  v_max3_f32 v134, v24, v25, v134
  v_max3_f32 v134, v26, v27, v134
  v_max3_f32 v134, v28, v29, v134
  v_max3_f32 v134, v30, v31, v134
  v_mfma_f32_32x32x16_bf16 v[16:31], a[44:47], v[220:223], 0
  v_mfma_f32_32x32x8_bf16 v[16:31], a[76:77], v[230:231], v[16:31]
  s_nop 11
  v_max3_f32 v134, v16, v17, v134
  v_max3_f32 v134, v18, v19, v134
  v_max3_f32 v134, v20, v21, v134
  v_max3_f32 v134, v22, v23, v134
  v_max3_f32 v134, v24, v25, v134
  v_max3_f32 v134, v26, v27, v134
  v_max3_f32 v134, v28, v29, v134
  v_max3_f32 v134, v30, v31, v134
  v_mfma_f32_32x32x16_bf16 v[16:31], a[48:51], v[220:223], 0
  v_mfma_f32_32x32x8_bf16 v[16:31], a[78:79], v[230:231], v[16:31]
  s_nop 11
  v_max3_f32 v134, v16, v17, v134
  v_max3_f32 v134, v18, v19, v134
  v_max3_f32 v134, v20, v21, v134
  v_max3_f32 v134, v22, v23, v134
  v_max3_f32 v134, v24, v25, v134
  v_max3_f32 v134, v26, v27, v134
  v_max3_f32 v134, v28, v29, v134
  v_max3_f32 v134, v30, v31, v134
  v_mfma_f32_32x32x16_bf16 v[16:31], a[52:55], v[220:223], 0
  v_mfma_f32_32x32x8_bf16 v[16:31], a[80:81], v[230:231], v[16:31]
  s_nop 11
  v_max3_f32 v134, v16, v17, v134
  v_max3_f32 v134, v18, v19, v134
  v_max3_f32 v134, v20, v21, v134
  v_max3_f32 v134, v22, v23, v134
  v_max3_f32 v134, v24, v25, v134
  v_max3_f32 v134, v26, v27, v134
  v_max3_f32 v134, v28, v29, v134
  v_max3_f32 v134, v30, v31, v134
  v_mfma_f32_32x32x16_bf16 v[16:31], a[56:59], v[220:223], 0
  v_mfma_f32_32x32x8_bf16 v[16:31], a[82:83], v[230:231], v[16:31]
  s_nop 11
  v_max3_f32 v134, v16, v17, v134
  v_max3_f32 v134, v18, v19, v134
  v_max3_f32 v134, v20, v21, v134
  v_max3_f32 v134, v22, v23, v134
  v_max3_f32 v134, v24, v25, v134
  v_max3_f32 v134, v26, v27, v134
  v_max3_f32 v134, v28, v29, v134
  v_max3_f32 v134, v30, v31, v134
  v_mfma_f32_32x32x16_bf16 v[16:31], a[60:63], v[220:223], 0
  v_mfma_f32_32x32x8_bf16 v[16:31], a[84:85], v[230:231], v[16:31]
  s_nop 11
  v_max3_f32 v134, v16, v17, v134
  v_max3_f32 v134, v18, v19, v134
  v_max3_f32 v134, v20, v21, v134
  v_max3_f32 v134, v22, v23, v134
  v_max3_f32 v134, v24, v25, v134
  v_max3_f32 v134, v26, v27, v134
  v_max3_f32 v134, v28, v29, v134
  v_max3_f32 v134, v30, v31, v134
  v_mfma_f32_32x32x16_bf16 v[16:31], a[64:67], v[220:223], 0
  v_mfma_f32_32x32x8_bf16 v[16:31], a[86:87], v[230:231], v[16:31]
  s_nop 11
  v_max3_f32 v134, v16, v17, v134
  v_max3_f32 v134, v18, v19, v134
  v_max3_f32 v134, v20, v21, v134
  v_max3_f32 v134, v22, v23, v134
  v_max3_f32 v134, v24, v25, v134
  v_max3_f32 v134, v26, v27, v134
  v_max3_f32 v134, v28, v29, v134
  v_max3_f32 v134, v30, v31, v134
  s_branch L_att
.section .rodata,"a"
.p2align 6
.amdhsa_kernel interleave_layers__sliding_block__glu_gated_swiglu__prompt_kernel
.amdhsa_next_free_vgpr 512
.amdhsa_next_free_sgpr 100
.amdhsa_accum_offset 256
.amdhsa_group_segment_fixed_size 0
.amdhsa_kernarg_size 80
.amdhsa_user_sgpr_count 2
.amdhsa_user_sgpr_kernarg_segment_ptr 1
.amdhsa_system_sgpr_workgroup_id_x 1
.end_amdhsa_kernel
```
